```python
import torch

def _softmax(x, axis=-1):
    return torch.softmax(x, dim=axis)
def _gelu(x):
    return torch.nn.functional.gelu(x, approximate="tanh")
def _silu(x):
    return torch.nn.functional.silu(x)
def _sigmoid(x):
    return torch.sigmoid(x)
def _layernorm(x, axis=-1, eps=1e-5):
    m = x.mean(dim=axis, keepdim=True)
    v = x.var(dim=axis, keepdim=True, unbiased=False)
    return (x - m) / torch.sqrt(v + eps)
def _scatter_add(tgt, idx, src, axis=0):
    return tgt.clone().index_add_(axis, idx, src)
def _segment_sum(src, seg, n):
    out = torch.zeros((n,) + src.shape[1:], dtype=src.dtype)
    return out.index_add_(0, seg, src)
def _pad(x, pw):
    flat = tuple(v for pair in reversed(pw) for v in pair)
    return torch.nn.functional.pad(x, flat)

kernel_name = 'concat_heads__gqa_block_cached__mha_block_cached__near_ridge'

def setup_inputs():

    _w = (lambda a: (lambda t: t.to(torch.bfloat16) if t.is_floating_point() else t)(torch.as_tensor(a)))
    def _A_setup():
        B, Sq, D = 16, 48, 576
        Hq, Hkv, Sk, Dh = 32, 16, 48, 128
        assert Hq % Hkv == 0, (Hq, Hkv)
        return {
            "x": _w((lambda *s: torch.randn(*s, dtype=torch.bfloat16) * 0.8)(B, Sq, D)),
            "k_cache": _w((lambda *s: torch.randn(*s, dtype=torch.bfloat16) * 0.8)(B, Hkv, Sk, Dh)),
            "v_cache": _w((lambda *s: torch.randn(*s, dtype=torch.bfloat16) * 0.05)(B, Hkv, Sk, Dh)),
            "wq": _w((lambda *s: torch.randn(*s, dtype=torch.bfloat16) * 0.8)(D, Hq * Dh) * (D ** -0.5)),
            "wo": _w((lambda *s: torch.randn(*s, dtype=torch.bfloat16) * 0.05)(Hq * Dh, D) * ((Hq * Dh) ** -0.5)),
        }
    _A_in = _A_setup()

    def _B_setup():
        B, Sq, D = 16, 48, 576
        H, Sk, Dh = 32, 48, 128
        return {
            "x": _w((lambda *s: torch.randn(*s, dtype=torch.bfloat16) * 0.8)(B, Sq, D)),
            "k_cache": _w((lambda *s: torch.randn(*s, dtype=torch.bfloat16) * 0.8)(B, H, Sk, Dh)),
            "v_cache": _w((lambda *s: torch.randn(*s, dtype=torch.bfloat16) * 0.05)(B, H, Sk, Dh)),
            "wq": _w((lambda *s: torch.randn(*s, dtype=torch.bfloat16) * 0.8)(D, H * Dh) * (D ** -0.5)),
            "wo": _w((lambda *s: torch.randn(*s, dtype=torch.bfloat16) * 0.05)(H * Dh, D) * ((H * Dh) ** -0.5)),
        }
    _B_in = _B_setup()

    return {
        "A_x": _A_in["x"],
        "A_k_cache": _A_in["k_cache"],
        "A_v_cache": _A_in["v_cache"],
        "A_wq": _A_in["wq"],
        "A_wo": _A_in["wo"],
        "B_x": _B_in["x"],
        "B_k_cache": _B_in["k_cache"],
        "B_v_cache": _B_in["v_cache"],
        "B_wq": _B_in["wq"],
        "B_wo": _B_in["wo"],
    }

def reference(A_x, A_k_cache, A_v_cache, A_wq, A_wo, B_x, B_k_cache, B_v_cache, B_wq, B_wo):
    def _A_ref(x, k_cache, v_cache, wq, wo):
        B, Sq, D = x.shape
        Hq, Dh = 32, 128
        Hkv = k_cache.shape[1]
        rep = Hq // Hkv
        q = (lambda x, *d: x.permute(*d))((x @ wq).reshape(B, Sq, Hq, Dh), 0, 2, 1, 3)
        k = (lambda x, n, axis: torch.repeat_interleave(x, n, dim=axis))(k_cache, rep, axis=1)
        v = (lambda x, n, axis: torch.repeat_interleave(x, n, dim=axis))(v_cache, rep, axis=1)
        scores = torch.einsum("bhqd,bhkd->bhqk", q, k) * (Dh ** -0.5)
        p = _softmax(scores, axis=-1)
        o = torch.einsum("bhqk,bhkd->bhqd", p, v)
        return (lambda x, *d: x.permute(*d))(o, 0, 2, 1, 3).reshape(B, Sq, Hq * Dh) @ wo

    def _B_ref(x, k_cache, v_cache, wq, wo):
        B, Sq, D = x.shape
        H, Dh = 32, 128
        q = (lambda x, *d: x.permute(*d))((x @ wq).reshape(B, Sq, H, Dh), 0, 2, 1, 3)
        scores = torch.einsum("bhqd,bhkd->bhqk", q, k_cache) * (Dh ** -0.5)
        p = _softmax(scores, axis=-1)
        o = torch.einsum("bhqk,bhkd->bhqd", p, v_cache)
        return (lambda x, *d: x.permute(*d))(o, 0, 2, 1, 3).reshape(B, Sq, H * Dh) @ wo

    a = _A_ref(A_x, A_k_cache, A_v_cache, A_wq, A_wo)
    b = _B_ref(B_x, B_k_cache, B_v_cache, B_wq, B_wo)
    return torch.concatenate([a, b], axis=-1)
```

```asm
; @launch grid=(256,1,1) block=(512,1,1) lds=163840
.amdgcn_target "amdgcn-amd-amdhsa--gfx950"
.text
.globl concat_heads__gqa_block_cached__mha_block_cached__near_ridge_kernel
.p2align 8
.type concat_heads__gqa_block_cached__mha_block_cached__near_ridge_kernel,@function
concat_heads__gqa_block_cached__mha_block_cached__near_ridge_kernel:
    s_cmp_ge_u32 s2, 256
    s_cbranch_scc1 L_end
    s_load_dwordx16 s[8:23], s[0:1], 0
    s_load_dwordx8 s[24:31], s[0:1], 64
    s_load_dwordx2 s[32:33], s[0:1], 96
    v_and_b32 v1, 63, v0
    v_lshrrev_b32 v15, 6, v0
    s_and_b32 s69, s2, 3
    s_bfe_u32 s68, s2, 0x10002
    s_xor_b32 s68, s68, 1
    s_bfe_u32 s70, s2, 0x30003
    s_lshr_b32 s71, s2, 6
    s_and_b32 s98, s70, 3
    v_readfirstlane_b32 s72, v15
    s_lshr_b32 s99, s70, 2
    s_xor_b32 s99, s99, s71
    s_and_b32 s99, s99, 1
    s_and_b32 s3, s71, 2
    s_or_b32 s3, s3, s99
    s_mov_b32 s99, 0
    s_cmp_lt_u32 s72, 4
    s_cbranch_scc1 L_compute
    s_sub_u32 s73, s72, 4
    s_getpc_b64 s[6:7]
Lpc_1:
    s_sub_u32 s6, s6, Lpc_1-concat_heads__gqa_block_cached__mha_block_cached__near_ridge_kernel
    s_subb_u32 s7, s7, 0
    s_lshr_b32 s76, s2, 3
    s_lshl_b32 s76, s76, 2
    s_add_u32 s76, s76, s73
    s_mul_i32 s76, s76, 384
    v_lshlrev_b32 v25, 7, v1
    v_add_u32 v25, s76, v25
    s_mov_b32 s77, L_code_end-concat_heads__gqa_block_cached__mha_block_cached__near_ridge_kernel-4
    v_min_u32 v24, s77, v25
    v_mov_b32 v25, s7
    v_add_co_u32 v24, vcc, s6, v24
    s_nop 1
    v_addc_co_u32 v25, vcc, 0, v25, vcc
    s_mov_b64 exec, 7
    global_load_dword v125, v[24:25], off
    s_mov_b64 exec, -1
    s_and_b32 s74, s73, 1
    s_lshr_b32 s75, s73, 1
    s_lshl_b32 s95, s69, 3
    s_add_u32 s95, s95, s70
    v_lshrrev_b32 v4, 4, v1
    s_lshl_b32 s76, s75, 2
    v_or_b32 v5, s76, v4
    v_bfe_u32 v6, v1, 1, 3
    v_xor_b32 v6, v6, v5
    v_lshlrev_b32 v6, 5, v6
    v_and_b32 v7, 1, v1
    v_lshl_add_u32 v6, v7, 4, v6
    v_lshl_add_u32 v2, v4, 13, v6
    s_lshl_b32 s76, s73, 15
    s_lshl_b32 s77, s95, 8
    s_add_u32 s76, s76, s77
    v_add_u32 v2, s76, v2
    v_lshlrev_b32 v5, 2, v4
    v_and_b32 v6, 15, v1
    v_xor_b32 v6, v6, v5
    v_lshlrev_b32 v6, 4, v6
    v_lshl_add_u32 v10, v4, 8, v6
    s_lshl_b32 s76, s74, 2
    v_or_b32 v5, s76, v4
    v_lshrrev_b32 v4, 3, v1
    v_mul_u32_u24 v4, 1152, v4
    v_and_b32 v6, 7, v1
    v_xor_b32 v6, v6, v5
    v_lshl_add_u32 v3, v6, 4, v4
    s_mul_i32 s76, s71, 221184
    s_mul_i32 s77, s74, 9216
    s_add_u32 s76, s76, s77
    s_mul_i32 s77, s75, 110592
    s_add_u32 s76, s76, s77
    v_add_u32 v3, s76, v3
    s_lshl_b32 s78, s73, 10
    s_mul_i32 s79, s75, 12288
    s_lshl_b32 s77, s74, 10
    s_add_u32 s79, s79, s77
    s_add_u32 s79, s79, 16384
    s_lshl_b32 s76, s71, 2
    s_add_u32 s76, s76, s73
    s_lshl_b32 s76, s76, 5
    s_add_u32 s76, s76, s95
    s_xor_b32 s77, s68, 1
    s_lshr_b32 s76, s76, s77
    s_mul_i32 s80, s76, 12288
    s_mul_i32 s91, s73, 1024
    s_add_u32 s91, s91, 0
    s_mul_i32 s92, s73, 1024
    s_add_u32 s84, s70, s71
    s_mul_i32 s85, s84, 43
    s_lshr_b32 s85, s85, 7
    s_mul_i32 s85, s85, 3
    s_sub_u32 s84, s84, s85
    s_mul_i32 s84, s84, 3
    s_waitcnt lgkmcnt(0)
    s_cmp_eq_u32 s68, 0
    s_cselect_b64 s[48:49], s[14:15], s[24:25]
    s_mov_b32 s50, 4718592
    s_mov_b32 s51, 0x20000
    s_cselect_b64 s[36:37], s[8:9], s[18:19]
    s_mov_b32 s38, 884736
    s_mov_b32 s39, 0x20000
    s_cselect_b64 s[40:41], s[10:11], s[20:21]
    s_mov_b32 s42, 6291456
    s_cselect_b32 s42, 3145728, s42
    s_mov_b32 s43, 0x20000
    s_lshl_b32 s85, s84, 7
    s_lshl_b32 s86, s84, 19
    s_add_u32 m0, s78, 40960
    s_add_u32 s82, s86, 0
    buffer_load_dwordx4 v2, s[48:51], s82 offen lds
    s_add_u32 m0, s78, 45056
    s_add_u32 s82, s86, 131072
    buffer_load_dwordx4 v2, s[48:51], s82 offen lds
    s_add_u32 m0, s78, 49152
    s_add_u32 s82, s86, 262144
    buffer_load_dwordx4 v2, s[48:51], s82 offen lds
    s_add_u32 m0, s78, 53248
    s_add_u32 s82, s86, 393216
    buffer_load_dwordx4 v2, s[48:51], s82 offen lds
    s_add_u32 m0, s79, 40960
    s_add_u32 s82, s85, 0
    buffer_load_dwordx4 v3, s[36:39], s82 offen lds
    s_add_u32 m0, s79, 43008
    s_add_u32 s82, s85, 18432
    buffer_load_dwordx4 v3, s[36:39], s82 offen lds
    s_add_u32 m0, s79, 45056
    s_add_u32 s82, s85, 36864
    buffer_load_dwordx4 v3, s[36:39], s82 offen lds
    s_add_u32 m0, s79, 47104
    s_add_u32 s82, s85, 55296
    buffer_load_dwordx4 v3, s[36:39], s82 offen lds
    s_add_u32 m0, s79, 49152
    s_add_u32 s82, s85, 73728
    buffer_load_dwordx4 v3, s[36:39], s82 offen lds
    s_add_u32 m0, s79, 51200
    s_add_u32 s82, s85, 92160
    buffer_load_dwordx4 v3, s[36:39], s82 offen lds
    s_add_u32 s84, s84, 1
    s_cmp_eq_u32 s84, 9
    s_cselect_b32 s84, 0, s84
    s_waitcnt lgkmcnt(0)
    s_cmp_eq_u32 s68, 0
    s_cselect_b64 s[44:45], s[12:13], s[22:23]
    s_mov_b32 s46, 6291456
    s_cselect_b32 s46, 3145728, s46
    s_mov_b32 s47, 0x20000
    s_cselect_b64 s[52:53], s[16:17], s[26:27]
    s_mov_b32 s54, 4718592
    s_mov_b32 s55, 0x20000
    s_mov_b32 s56, s28
    s_mov_b32 s57, s29
    s_mov_b32 s58, 1769472
    s_mov_b32 s59, 0x20000
    s_mov_b32 s64, s30
    s_mov_b32 s65, s31
    s_mov_b32 s66, 256
    s_mov_b32 s67, 0x20000
    s_mov_b32 s60, s32
    s_mov_b32 s61, s33
    s_mov_b32 s62, 83886080
    s_mov_b32 s63, 0x20000
    v_mov_b32 v16, 0
    s_add_u32 s76, s2, s73
    s_cmp_lg_u32 s76, 0
    s_cbranch_scc1 Lnw_2
    s_memrealtime s[88:89]
    s_waitcnt lgkmcnt(0)
    s_or_b32 s88, s88, 1
    v_mov_b32 v18, s88
    v_mov_b32 v19, s89
    s_mov_b64 exec, 1
    buffer_store_dwordx2 v[18:19], v16, s[64:67], 0 offen sc1
    s_mov_b64 exec, -1
Lnw_2:
    s_lshl_b32 s85, s84, 7
    s_lshl_b32 s86, s84, 19
    s_add_u32 m0, s78, 81920
    s_add_u32 s82, s86, 0
    buffer_load_dwordx4 v2, s[48:51], s82 offen lds
    s_add_u32 m0, s78, 86016
    s_add_u32 s82, s86, 131072
    buffer_load_dwordx4 v2, s[48:51], s82 offen lds
    s_add_u32 m0, s78, 90112
    s_add_u32 s82, s86, 262144
    buffer_load_dwordx4 v2, s[48:51], s82 offen lds
    s_add_u32 m0, s78, 94208
    s_add_u32 s82, s86, 393216
    buffer_load_dwordx4 v2, s[48:51], s82 offen lds
    s_add_u32 m0, s79, 81920
    s_add_u32 s82, s85, 0
    buffer_load_dwordx4 v3, s[36:39], s82 offen lds
    s_add_u32 m0, s79, 83968
    s_add_u32 s82, s85, 18432
    buffer_load_dwordx4 v3, s[36:39], s82 offen lds
    s_add_u32 m0, s79, 86016
    s_add_u32 s82, s85, 36864
    buffer_load_dwordx4 v3, s[36:39], s82 offen lds
    s_add_u32 m0, s79, 88064
    s_add_u32 s82, s85, 55296
    buffer_load_dwordx4 v3, s[36:39], s82 offen lds
    s_add_u32 m0, s79, 90112
    s_add_u32 s82, s85, 73728
    buffer_load_dwordx4 v3, s[36:39], s82 offen lds
    s_add_u32 m0, s79, 92160
    s_add_u32 s82, s85, 92160
    buffer_load_dwordx4 v3, s[36:39], s82 offen lds
    s_add_u32 s84, s84, 1
    s_cmp_eq_u32 s84, 9
    s_cselect_b32 s84, 0, s84
    s_and_b32 s76, s95, 0xfc
    s_lshl_b32 s76, s76, 7
    s_lshl_b32 s77, s73, 5
    s_add_u32 s76, s76, s77
    s_mul_i32 s76, s76, 1152
    s_mul_i32 s77, s98, 288
    s_and_b32 s77, s77, 0xffffffc0
    s_add_u32 s76, s76, s77
    v_add_u32 v4, 0, v1
    v_mul_u32_u24 v5, 3277, v4
    v_lshrrev_b32 v5, 16, v5
    v_mul_u32_u24 v6, 20, v5
    v_sub_u32 v6, v4, v6
    v_bfe_u32 v7, v5, 2, 1
    v_lshlrev_b32 v7, 1, v7
    v_xor_b32 v6, v6, v7
    v_mul_u32_u24 v5, 1152, v5
    v_lshl_add_u32 v5, v6, 4, v5
    v_add_u32 v26, s76, v5
    v_add_u32 v4, 64, v1
    v_mul_u32_u24 v5, 3277, v4
    v_lshrrev_b32 v5, 16, v5
    v_mul_u32_u24 v6, 20, v5
    v_sub_u32 v6, v4, v6
    v_bfe_u32 v7, v5, 2, 1
    v_lshlrev_b32 v7, 1, v7
    v_xor_b32 v6, v6, v7
    v_mul_u32_u24 v5, 1152, v5
    v_lshl_add_u32 v5, v6, 4, v5
    v_add_u32 v27, s76, v5
    v_add_u32 v4, 128, v1
    v_mul_u32_u24 v5, 3277, v4
    v_lshrrev_b32 v5, 16, v5
    v_mul_u32_u24 v6, 20, v5
    v_sub_u32 v6, v4, v6
    v_bfe_u32 v7, v5, 2, 1
    v_lshlrev_b32 v7, 1, v7
    v_xor_b32 v6, v6, v7
    v_mul_u32_u24 v5, 1152, v5
    v_lshl_add_u32 v5, v6, 4, v5
    v_add_u32 v28, s76, v5
    v_add_u32 v4, 192, v1
    v_mul_u32_u24 v5, 3277, v4
    v_lshrrev_b32 v5, 16, v5
    v_mul_u32_u24 v6, 20, v5
    v_sub_u32 v6, v4, v6
    v_bfe_u32 v7, v5, 2, 1
    v_lshlrev_b32 v7, 1, v7
    v_xor_b32 v6, v6, v7
    v_mul_u32_u24 v5, 1152, v5
    v_lshl_add_u32 v5, v6, 4, v5
    v_add_u32 v29, s76, v5
    v_add_u32 v4, 256, v1
    v_mul_u32_u24 v5, 3277, v4
    v_lshrrev_b32 v5, 16, v5
    v_mul_u32_u24 v6, 20, v5
    v_sub_u32 v6, v4, v6
    v_bfe_u32 v7, v5, 2, 1
    v_lshlrev_b32 v7, 1, v7
    v_xor_b32 v6, v6, v7
    v_mul_u32_u24 v5, 1152, v5
    v_lshl_add_u32 v5, v6, 4, v5
    v_add_u32 v30, s76, v5
    s_mul_i32 s93, s73, 10240
    v_lshlrev_b32 v20, 4, v1
    v_add_u32 v20, s93, v20
    v_lshlrev_b32 v22, 7, v1
    s_and_b32 s76, s71, 1
    s_lshl_b32 s76, s76, 2
    s_add_u32 s76, s76, s98
    s_lshl_b32 s76, s76, 2
    s_add_u32 s76, s76, s73
    s_mul_i32 s76, s76, 36864
    s_mul_i32 s94, s69, 1179648
    s_add_u32 s94, s94, s76
    s_waitcnt vmcnt(10)
    s_barrier
    s_lshl_b32 s85, s84, 7
    s_lshl_b32 s86, s84, 19
    s_add_u32 m0, s78, 122880
    s_add_u32 s82, s86, 0
    buffer_load_dwordx4 v2, s[48:51], s82 offen lds
    s_add_u32 m0, s78, 126976
    s_add_u32 s82, s86, 131072
    buffer_load_dwordx4 v2, s[48:51], s82 offen lds
    s_add_u32 m0, s78, 131072
    s_add_u32 s82, s86, 262144
    buffer_load_dwordx4 v2, s[48:51], s82 offen lds
    s_add_u32 m0, s78, 135168
    s_add_u32 s82, s86, 393216
    buffer_load_dwordx4 v2, s[48:51], s82 offen lds
    s_add_u32 m0, s79, 122880
    s_add_u32 s82, s85, 0
    buffer_load_dwordx4 v3, s[36:39], s82 offen lds
    s_add_u32 m0, s79, 124928
    s_add_u32 s82, s85, 18432
    buffer_load_dwordx4 v3, s[36:39], s82 offen lds
    s_add_u32 m0, s79, 126976
    s_add_u32 s82, s85, 36864
    buffer_load_dwordx4 v3, s[36:39], s82 offen lds
    s_add_u32 m0, s79, 129024
    s_add_u32 s82, s85, 55296
    buffer_load_dwordx4 v3, s[36:39], s82 offen lds
    s_add_u32 m0, s79, 131072
    s_add_u32 s82, s85, 73728
    buffer_load_dwordx4 v3, s[36:39], s82 offen lds
    s_add_u32 m0, s79, 133120
    s_add_u32 s82, s85, 92160
    buffer_load_dwordx4 v3, s[36:39], s82 offen lds
    s_add_u32 s84, s84, 1
    s_cmp_eq_u32 s84, 9
    s_cselect_b32 s84, 0, s84
    s_waitcnt vmcnt(10)
    s_barrier
    s_lshl_b32 s85, s84, 7
    s_lshl_b32 s86, s84, 19
    s_add_u32 m0, s78, 40960
    s_add_u32 s82, s86, 0
    buffer_load_dwordx4 v2, s[48:51], s82 offen lds
    s_add_u32 m0, s78, 45056
    s_add_u32 s82, s86, 131072
    buffer_load_dwordx4 v2, s[48:51], s82 offen lds
    s_add_u32 m0, s78, 49152
    s_add_u32 s82, s86, 262144
    buffer_load_dwordx4 v2, s[48:51], s82 offen lds
    s_add_u32 m0, s78, 53248
    s_add_u32 s82, s86, 393216
    buffer_load_dwordx4 v2, s[48:51], s82 offen lds
    s_add_u32 m0, s79, 40960
    s_add_u32 s82, s85, 0
    buffer_load_dwordx4 v3, s[36:39], s82 offen lds
    s_add_u32 m0, s79, 43008
    s_add_u32 s82, s85, 18432
    buffer_load_dwordx4 v3, s[36:39], s82 offen lds
    s_add_u32 m0, s79, 45056
    s_add_u32 s82, s85, 36864
    buffer_load_dwordx4 v3, s[36:39], s82 offen lds
    s_add_u32 m0, s79, 47104
    s_add_u32 s82, s85, 55296
    buffer_load_dwordx4 v3, s[36:39], s82 offen lds
    s_add_u32 m0, s79, 49152
    s_add_u32 s82, s85, 73728
    buffer_load_dwordx4 v3, s[36:39], s82 offen lds
    s_add_u32 m0, s79, 51200
    s_add_u32 s82, s85, 92160
    buffer_load_dwordx4 v3, s[36:39], s82 offen lds
    s_add_u32 s84, s84, 1
    s_cmp_eq_u32 s84, 9
    s_cselect_b32 s84, 0, s84
    s_waitcnt vmcnt(10)
    s_barrier
    s_lshl_b32 s85, s84, 7
    s_lshl_b32 s86, s84, 19
    s_add_u32 m0, s78, 81920
    s_add_u32 s82, s86, 0
    buffer_load_dwordx4 v2, s[48:51], s82 offen lds
    s_add_u32 m0, s78, 86016
    s_add_u32 s82, s86, 131072
    buffer_load_dwordx4 v2, s[48:51], s82 offen lds
    s_add_u32 m0, s78, 90112
    s_add_u32 s82, s86, 262144
    buffer_load_dwordx4 v2, s[48:51], s82 offen lds
    s_add_u32 m0, s78, 94208
    s_add_u32 s82, s86, 393216
    buffer_load_dwordx4 v2, s[48:51], s82 offen lds
    s_add_u32 m0, s79, 81920
    s_add_u32 s82, s85, 0
    buffer_load_dwordx4 v3, s[36:39], s82 offen lds
    s_add_u32 m0, s79, 83968
    s_add_u32 s82, s85, 18432
    buffer_load_dwordx4 v3, s[36:39], s82 offen lds
    s_add_u32 m0, s79, 86016
    s_add_u32 s82, s85, 36864
    buffer_load_dwordx4 v3, s[36:39], s82 offen lds
    s_add_u32 m0, s79, 88064
    s_add_u32 s82, s85, 55296
    buffer_load_dwordx4 v3, s[36:39], s82 offen lds
    s_add_u32 m0, s79, 90112
    s_add_u32 s82, s85, 73728
    buffer_load_dwordx4 v3, s[36:39], s82 offen lds
    s_add_u32 m0, s79, 92160
    s_add_u32 s82, s85, 92160
    buffer_load_dwordx4 v3, s[36:39], s82 offen lds
    s_add_u32 s84, s84, 1
    s_cmp_eq_u32 s84, 9
    s_cselect_b32 s84, 0, s84
    s_cmp_eq_u32 s3, 1
    s_cbranch_scc1 L_cls1
    s_cmp_eq_u32 s3, 2
    s_cbranch_scc1 L_cls2
    s_cmp_eq_u32 s3, 3
    s_cbranch_scc1 L_cls3
    s_waitcnt vmcnt(10)
    s_barrier
    s_add_u32 m0, s91, 0
    s_add_u32 s82, s80, 0
    buffer_load_dwordx4 v10, s[40:43], s82 offen nt lds
    s_add_u32 m0, s91, 4112
    s_add_u32 s82, s80, 1024
    buffer_load_dwordx4 v10, s[40:43], s82 offen nt lds
    s_add_u32 m0, s91, 8224
    s_add_u32 s82, s80, 2048
    buffer_load_dwordx4 v10, s[40:43], s82 offen nt lds
    s_add_u32 m0, s91, 12336
    s_add_u32 s82, s80, 3072
    buffer_load_dwordx4 v10, s[40:43], s82 offen nt lds
    s_add_u32 m0, s91, 16448
    s_add_u32 s82, s80, 4096
    buffer_load_dwordx4 v10, s[40:43], s82 offen nt lds
    s_add_u32 m0, s91, 20560
    s_add_u32 s82, s80, 5120
    buffer_load_dwordx4 v10, s[40:43], s82 offen nt lds
    s_add_u32 m0, s91, 24672
    s_add_u32 s82, s80, 6144
    buffer_load_dwordx4 v10, s[40:43], s82 offen nt lds
    s_add_u32 m0, s91, 28784
    s_add_u32 s82, s80, 7168
    buffer_load_dwordx4 v10, s[40:43], s82 offen nt lds
    s_add_u32 m0, s91, 32896
    s_add_u32 s82, s80, 8192
    buffer_load_dwordx4 v10, s[40:43], s82 offen nt lds
    s_mov_b32 exec_lo, -1
    s_mov_b32 exec_hi, 15
    s_add_u32 s82, s94, 0
    buffer_load_dword v23, v22, s[52:55], s82 offen
    s_add_u32 s82, s94, 4608
    buffer_load_dword v23, v22, s[52:55], s82 offen
    s_mov_b64 exec, -1
    s_waitcnt vmcnt(11)
    s_barrier
    s_mov_b64 exec, 7
    global_load_dword v125, v[24:25], off
    s_mov_b64 exec, -1
    s_lshl_b32 s85, s84, 7
    s_lshl_b32 s86, s84, 19
    s_add_u32 m0, s78, 122880
    s_add_u32 s82, s86, 0
    buffer_load_dwordx4 v2, s[48:51], s82 offen lds
    s_add_u32 m0, s78, 126976
    s_add_u32 s82, s86, 131072
    buffer_load_dwordx4 v2, s[48:51], s82 offen lds
    s_add_u32 m0, s78, 131072
    s_add_u32 s82, s86, 262144
    buffer_load_dwordx4 v2, s[48:51], s82 offen lds
    s_add_u32 m0, s78, 135168
    s_add_u32 s82, s86, 393216
    buffer_load_dwordx4 v2, s[48:51], s82 offen lds
    s_add_u32 m0, s79, 122880
    s_add_u32 s82, s85, 0
    buffer_load_dwordx4 v3, s[36:39], s82 offen lds
    s_add_u32 m0, s79, 124928
    s_add_u32 s82, s85, 18432
    buffer_load_dwordx4 v3, s[36:39], s82 offen lds
    s_add_u32 m0, s79, 126976
    s_add_u32 s82, s85, 36864
    buffer_load_dwordx4 v3, s[36:39], s82 offen lds
    s_add_u32 m0, s79, 129024
    s_add_u32 s82, s85, 55296
    buffer_load_dwordx4 v3, s[36:39], s82 offen lds
    s_add_u32 m0, s79, 131072
    s_add_u32 s82, s85, 73728
    buffer_load_dwordx4 v3, s[36:39], s82 offen lds
    s_add_u32 m0, s79, 133120
    s_add_u32 s82, s85, 92160
    buffer_load_dwordx4 v3, s[36:39], s82 offen lds
    s_add_u32 s84, s84, 1
    s_cmp_eq_u32 s84, 9
    s_cselect_b32 s84, 0, s84
    s_lshl_b32 s85, s84, 7
    s_lshl_b32 s86, s84, 19
    s_add_u32 m0, s78, 40960
    s_add_u32 s82, s86, 0
    buffer_load_dwordx4 v2, s[48:51], s82 offen lds
    s_add_u32 m0, s78, 45056
    s_add_u32 s82, s86, 131072
    buffer_load_dwordx4 v2, s[48:51], s82 offen lds
    s_add_u32 m0, s78, 49152
    s_add_u32 s82, s86, 262144
    buffer_load_dwordx4 v2, s[48:51], s82 offen lds
    s_add_u32 m0, s78, 53248
    s_add_u32 s82, s86, 393216
    buffer_load_dwordx4 v2, s[48:51], s82 offen lds
    s_add_u32 m0, s79, 40960
    s_add_u32 s82, s85, 0
    buffer_load_dwordx4 v3, s[36:39], s82 offen lds
    s_add_u32 m0, s79, 43008
    s_add_u32 s82, s85, 18432
    buffer_load_dwordx4 v3, s[36:39], s82 offen lds
    s_add_u32 m0, s79, 45056
    s_add_u32 s82, s85, 36864
    buffer_load_dwordx4 v3, s[36:39], s82 offen lds
    s_add_u32 m0, s79, 47104
    s_add_u32 s82, s85, 55296
    buffer_load_dwordx4 v3, s[36:39], s82 offen lds
    s_add_u32 m0, s79, 49152
    s_add_u32 s82, s85, 73728
    buffer_load_dwordx4 v3, s[36:39], s82 offen lds
    s_add_u32 m0, s79, 51200
    s_add_u32 s82, s85, 92160
    buffer_load_dwordx4 v3, s[36:39], s82 offen lds
    s_add_u32 s84, s84, 1
    s_cmp_eq_u32 s84, 9
    s_cselect_b32 s84, 0, s84
    s_waitcnt vmcnt(10)
    s_barrier
    s_lshl_b32 s85, s84, 7
    s_lshl_b32 s86, s84, 19
    s_add_u32 m0, s78, 81920
    s_add_u32 s82, s86, 0
    buffer_load_dwordx4 v2, s[48:51], s82 offen lds
    s_add_u32 m0, s78, 86016
    s_add_u32 s82, s86, 131072
    buffer_load_dwordx4 v2, s[48:51], s82 offen lds
    s_add_u32 m0, s78, 90112
    s_add_u32 s82, s86, 262144
    buffer_load_dwordx4 v2, s[48:51], s82 offen lds
    s_add_u32 m0, s78, 94208
    s_add_u32 s82, s86, 393216
    buffer_load_dwordx4 v2, s[48:51], s82 offen lds
    s_add_u32 m0, s79, 81920
    s_add_u32 s82, s85, 0
    buffer_load_dwordx4 v3, s[36:39], s82 offen lds
    s_add_u32 m0, s79, 83968
    s_add_u32 s82, s85, 18432
    buffer_load_dwordx4 v3, s[36:39], s82 offen lds
    s_add_u32 m0, s79, 86016
    s_add_u32 s82, s85, 36864
    buffer_load_dwordx4 v3, s[36:39], s82 offen lds
    s_add_u32 m0, s79, 88064
    s_add_u32 s82, s85, 55296
    buffer_load_dwordx4 v3, s[36:39], s82 offen lds
    s_add_u32 m0, s79, 90112
    s_add_u32 s82, s85, 73728
    buffer_load_dwordx4 v3, s[36:39], s82 offen lds
    s_add_u32 m0, s79, 92160
    s_add_u32 s82, s85, 92160
    buffer_load_dwordx4 v3, s[36:39], s82 offen lds
    s_add_u32 s84, s84, 1
    s_cmp_eq_u32 s84, 9
    s_cselect_b32 s84, 0, s84
    s_waitcnt vmcnt(10)
    s_barrier
    s_lshl_b32 s85, s84, 7
    s_lshl_b32 s86, s84, 19
    s_add_u32 m0, s78, 122880
    s_add_u32 s82, s86, 0
    buffer_load_dwordx4 v2, s[48:51], s82 offen lds
    s_add_u32 m0, s78, 126976
    s_add_u32 s82, s86, 131072
    buffer_load_dwordx4 v2, s[48:51], s82 offen lds
    s_add_u32 m0, s78, 131072
    s_add_u32 s82, s86, 262144
    buffer_load_dwordx4 v2, s[48:51], s82 offen lds
    s_add_u32 m0, s78, 135168
    s_add_u32 s82, s86, 393216
    buffer_load_dwordx4 v2, s[48:51], s82 offen lds
    s_add_u32 m0, s79, 122880
    s_add_u32 s82, s85, 0
    buffer_load_dwordx4 v3, s[36:39], s82 offen lds
    s_add_u32 m0, s79, 124928
    s_add_u32 s82, s85, 18432
    buffer_load_dwordx4 v3, s[36:39], s82 offen lds
    s_add_u32 m0, s79, 126976
    s_add_u32 s82, s85, 36864
    buffer_load_dwordx4 v3, s[36:39], s82 offen lds
    s_add_u32 m0, s79, 129024
    s_add_u32 s82, s85, 55296
    buffer_load_dwordx4 v3, s[36:39], s82 offen lds
    s_add_u32 m0, s79, 131072
    s_add_u32 s82, s85, 73728
    buffer_load_dwordx4 v3, s[36:39], s82 offen lds
    s_add_u32 m0, s79, 133120
    s_add_u32 s82, s85, 92160
    buffer_load_dwordx4 v3, s[36:39], s82 offen lds
    s_add_u32 s84, s84, 1
    s_cmp_eq_u32 s84, 9
    s_cselect_b32 s84, 0, s84
    s_waitcnt vmcnt(10)
    s_barrier
    s_add_u32 m0, s91, 37008
    s_add_u32 s82, s80, 9216
    buffer_load_dwordx4 v10, s[40:43], s82 offen nt lds
    s_add_u32 m0, s91, 41120
    s_add_u32 s82, s80, 10240
    buffer_load_dwordx4 v10, s[40:43], s82 offen nt lds
    s_add_u32 m0, s91, 45232
    s_add_u32 s82, s80, 11264
    buffer_load_dwordx4 v10, s[40:43], s82 offen nt lds
    s_add_u32 m0, s92, 49344
    s_add_u32 s82, s80, 0
    buffer_load_dwordx4 v10, s[44:47], s82 offen nt lds
    s_add_u32 m0, s92, 53472
    s_add_u32 s82, s80, 1024
    buffer_load_dwordx4 v10, s[44:47], s82 offen nt lds
    s_add_u32 m0, s92, 57600
    s_add_u32 s82, s80, 2048
    buffer_load_dwordx4 v10, s[44:47], s82 offen nt lds
    s_add_u32 m0, s92, 61728
    s_add_u32 s82, s80, 3072
    buffer_load_dwordx4 v10, s[44:47], s82 offen nt lds
    s_waitcnt vmcnt(7)
    s_barrier
    s_add_u32 m0, s92, 65856
    s_add_u32 s82, s80, 4096
    buffer_load_dwordx4 v10, s[44:47], s82 offen nt lds
    s_add_u32 m0, s92, 69984
    s_add_u32 s82, s80, 5120
    buffer_load_dwordx4 v10, s[44:47], s82 offen nt lds
    s_add_u32 m0, s92, 74112
    s_add_u32 s82, s80, 6144
    buffer_load_dwordx4 v10, s[44:47], s82 offen nt lds
    s_add_u32 m0, s92, 78240
    s_add_u32 s82, s80, 7168
    buffer_load_dwordx4 v10, s[44:47], s82 offen nt lds
    s_add_u32 m0, s92, 82368
    s_add_u32 s82, s80, 8192
    buffer_load_dwordx4 v10, s[44:47], s82 offen nt lds
    s_add_u32 m0, s92, 86496
    s_add_u32 s82, s80, 9216
    buffer_load_dwordx4 v10, s[44:47], s82 offen nt lds
    s_add_u32 m0, s92, 90624
    s_add_u32 s82, s80, 10240
    buffer_load_dwordx4 v10, s[44:47], s82 offen nt lds
    s_add_u32 m0, s92, 94752
    s_add_u32 s82, s80, 11264
    buffer_load_dwordx4 v10, s[44:47], s82 offen nt lds
    s_waitcnt vmcnt(12)
    s_barrier
    s_mov_b32 s83, s98
    s_mul_i32 s83, s83, 147456
    s_add_u32 s82, s83, 0
    s_add_u32 m0, s93, 122880
    s_nop 0
    buffer_load_dwordx4 v26, s[52:55], s82 offen lds
    s_add_u32 m0, s93, 123904
    s_nop 0
    buffer_load_dwordx4 v27, s[52:55], s82 offen lds
    s_add_u32 m0, s93, 124928
    s_nop 0
    buffer_load_dwordx4 v28, s[52:55], s82 offen lds
    s_add_u32 m0, s93, 125952
    s_nop 0
    buffer_load_dwordx4 v29, s[52:55], s82 offen lds
    s_add_u32 m0, s93, 126976
    s_nop 0
    buffer_load_dwordx4 v30, s[52:55], s82 offen lds
    s_add_u32 s82, s83, 18432
    s_add_u32 m0, s93, 128000
    s_nop 0
    buffer_load_dwordx4 v26, s[52:55], s82 offen lds
    s_add_u32 m0, s93, 129024
    s_nop 0
    buffer_load_dwordx4 v27, s[52:55], s82 offen lds
    s_add_u32 m0, s93, 130048
    s_nop 0
    buffer_load_dwordx4 v28, s[52:55], s82 offen lds
    s_add_u32 m0, s93, 131072
    s_nop 0
    buffer_load_dwordx4 v29, s[52:55], s82 offen lds
    s_add_u32 m0, s93, 132096
    s_nop 0
    buffer_load_dwordx4 v30, s[52:55], s82 offen lds
    s_cmp_le_u32 s98, 0
    s_cselect_b32 s83, 1, 0
    s_mul_i32 s83, s83, 147456
    s_add_u32 s87, s83, 18432
    buffer_load_dwordx4 v[40:43], v26, s[52:55], s83 offen
    buffer_load_dwordx4 v[44:47], v27, s[52:55], s83 offen
    buffer_load_dwordx4 v[48:51], v28, s[52:55], s83 offen
    buffer_load_dwordx4 v[52:55], v29, s[52:55], s83 offen
    buffer_load_dwordx4 v[56:59], v30, s[52:55], s83 offen
    buffer_load_dwordx4 v[60:63], v26, s[52:55], s87 offen
    buffer_load_dwordx4 v[64:67], v27, s[52:55], s87 offen
    buffer_load_dwordx4 v[68:71], v28, s[52:55], s87 offen
    buffer_load_dwordx4 v[72:75], v29, s[52:55], s87 offen
    buffer_load_dwordx4 v[76:79], v30, s[52:55], s87 offen
    s_waitcnt vmcnt(20)
    s_branch L_join
L_cls1:
    s_waitcnt vmcnt(10)
    s_barrier
    s_lshl_b32 s85, s84, 7
    s_lshl_b32 s86, s84, 19
    s_add_u32 m0, s78, 122880
    s_add_u32 s82, s86, 0
    buffer_load_dwordx4 v2, s[48:51], s82 offen lds
    s_add_u32 m0, s78, 126976
    s_add_u32 s82, s86, 131072
    buffer_load_dwordx4 v2, s[48:51], s82 offen lds
    s_add_u32 m0, s78, 131072
    s_add_u32 s82, s86, 262144
    buffer_load_dwordx4 v2, s[48:51], s82 offen lds
    s_add_u32 m0, s78, 135168
    s_add_u32 s82, s86, 393216
    buffer_load_dwordx4 v2, s[48:51], s82 offen lds
    s_add_u32 m0, s79, 122880
    s_add_u32 s82, s85, 0
    buffer_load_dwordx4 v3, s[36:39], s82 offen lds
    s_add_u32 m0, s79, 124928
    s_add_u32 s82, s85, 18432
    buffer_load_dwordx4 v3, s[36:39], s82 offen lds
    s_add_u32 m0, s79, 126976
    s_add_u32 s82, s85, 36864
    buffer_load_dwordx4 v3, s[36:39], s82 offen lds
    s_add_u32 m0, s79, 129024
    s_add_u32 s82, s85, 55296
    buffer_load_dwordx4 v3, s[36:39], s82 offen lds
    s_add_u32 m0, s79, 131072
    s_add_u32 s82, s85, 73728
    buffer_load_dwordx4 v3, s[36:39], s82 offen lds
    s_add_u32 m0, s79, 133120
    s_add_u32 s82, s85, 92160
    buffer_load_dwordx4 v3, s[36:39], s82 offen lds
    s_add_u32 s84, s84, 1
    s_cmp_eq_u32 s84, 9
    s_cselect_b32 s84, 0, s84
    s_waitcnt vmcnt(10)
    s_barrier
    s_mov_b64 exec, 7
    global_load_dword v125, v[24:25], off
    s_mov_b64 exec, -1
    s_add_u32 m0, s91, 0
    s_add_u32 s82, s80, 0
    buffer_load_dwordx4 v10, s[40:43], s82 offen nt lds
    s_add_u32 m0, s91, 4112
    s_add_u32 s82, s80, 1024
    buffer_load_dwordx4 v10, s[40:43], s82 offen nt lds
    s_add_u32 m0, s91, 8224
    s_add_u32 s82, s80, 2048
    buffer_load_dwordx4 v10, s[40:43], s82 offen nt lds
    s_add_u32 m0, s91, 12336
    s_add_u32 s82, s80, 3072
    buffer_load_dwordx4 v10, s[40:43], s82 offen nt lds
    s_add_u32 m0, s91, 16448
    s_add_u32 s82, s80, 4096
    buffer_load_dwordx4 v10, s[40:43], s82 offen nt lds
    s_add_u32 m0, s91, 20560
    s_add_u32 s82, s80, 5120
    buffer_load_dwordx4 v10, s[40:43], s82 offen nt lds
    s_add_u32 m0, s91, 24672
    s_add_u32 s82, s80, 6144
    buffer_load_dwordx4 v10, s[40:43], s82 offen nt lds
    s_add_u32 m0, s91, 28784
    s_add_u32 s82, s80, 7168
    buffer_load_dwordx4 v10, s[40:43], s82 offen nt lds
    s_add_u32 m0, s91, 32896
    s_add_u32 s82, s80, 8192
    buffer_load_dwordx4 v10, s[40:43], s82 offen nt lds
    s_mov_b32 exec_lo, -1
    s_mov_b32 exec_hi, 15
    s_add_u32 s82, s94, 9216
    buffer_load_dword v23, v22, s[52:55], s82 offen
    s_add_u32 s82, s94, 13824
    buffer_load_dword v23, v22, s[52:55], s82 offen
    s_mov_b64 exec, -1
    s_waitcnt vmcnt(12)
    s_barrier
    s_lshl_b32 s85, s84, 7
    s_lshl_b32 s86, s84, 19
    s_add_u32 m0, s78, 40960
    s_add_u32 s82, s86, 0
    buffer_load_dwordx4 v2, s[48:51], s82 offen lds
    s_add_u32 m0, s78, 45056
    s_add_u32 s82, s86, 131072
    buffer_load_dwordx4 v2, s[48:51], s82 offen lds
    s_add_u32 m0, s78, 49152
    s_add_u32 s82, s86, 262144
    buffer_load_dwordx4 v2, s[48:51], s82 offen lds
    s_add_u32 m0, s78, 53248
    s_add_u32 s82, s86, 393216
    buffer_load_dwordx4 v2, s[48:51], s82 offen lds
    s_add_u32 m0, s79, 40960
    s_add_u32 s82, s85, 0
    buffer_load_dwordx4 v3, s[36:39], s82 offen lds
    s_add_u32 m0, s79, 43008
    s_add_u32 s82, s85, 18432
    buffer_load_dwordx4 v3, s[36:39], s82 offen lds
    s_add_u32 m0, s79, 45056
    s_add_u32 s82, s85, 36864
    buffer_load_dwordx4 v3, s[36:39], s82 offen lds
    s_add_u32 m0, s79, 47104
    s_add_u32 s82, s85, 55296
    buffer_load_dwordx4 v3, s[36:39], s82 offen lds
    s_add_u32 m0, s79, 49152
    s_add_u32 s82, s85, 73728
    buffer_load_dwordx4 v3, s[36:39], s82 offen lds
    s_add_u32 m0, s79, 51200
    s_add_u32 s82, s85, 92160
    buffer_load_dwordx4 v3, s[36:39], s82 offen lds
    s_add_u32 s84, s84, 1
    s_cmp_eq_u32 s84, 9
    s_cselect_b32 s84, 0, s84
    s_lshl_b32 s85, s84, 7
    s_lshl_b32 s86, s84, 19
    s_add_u32 m0, s78, 81920
    s_add_u32 s82, s86, 0
    buffer_load_dwordx4 v2, s[48:51], s82 offen lds
    s_add_u32 m0, s78, 86016
    s_add_u32 s82, s86, 131072
    buffer_load_dwordx4 v2, s[48:51], s82 offen lds
    s_add_u32 m0, s78, 90112
    s_add_u32 s82, s86, 262144
    buffer_load_dwordx4 v2, s[48:51], s82 offen lds
    s_add_u32 m0, s78, 94208
    s_add_u32 s82, s86, 393216
    buffer_load_dwordx4 v2, s[48:51], s82 offen lds
    s_add_u32 m0, s79, 81920
    s_add_u32 s82, s85, 0
    buffer_load_dwordx4 v3, s[36:39], s82 offen lds
    s_add_u32 m0, s79, 83968
    s_add_u32 s82, s85, 18432
    buffer_load_dwordx4 v3, s[36:39], s82 offen lds
    s_add_u32 m0, s79, 86016
    s_add_u32 s82, s85, 36864
    buffer_load_dwordx4 v3, s[36:39], s82 offen lds
    s_add_u32 m0, s79, 88064
    s_add_u32 s82, s85, 55296
    buffer_load_dwordx4 v3, s[36:39], s82 offen lds
    s_add_u32 m0, s79, 90112
    s_add_u32 s82, s85, 73728
    buffer_load_dwordx4 v3, s[36:39], s82 offen lds
    s_add_u32 m0, s79, 92160
    s_add_u32 s82, s85, 92160
    buffer_load_dwordx4 v3, s[36:39], s82 offen lds
    s_add_u32 s84, s84, 1
    s_cmp_eq_u32 s84, 9
    s_cselect_b32 s84, 0, s84
    s_waitcnt vmcnt(10)
    s_barrier
    s_lshl_b32 s85, s84, 7
    s_lshl_b32 s86, s84, 19
    s_add_u32 m0, s78, 122880
    s_add_u32 s82, s86, 0
    buffer_load_dwordx4 v2, s[48:51], s82 offen lds
    s_add_u32 m0, s78, 126976
    s_add_u32 s82, s86, 131072
    buffer_load_dwordx4 v2, s[48:51], s82 offen lds
    s_add_u32 m0, s78, 131072
    s_add_u32 s82, s86, 262144
    buffer_load_dwordx4 v2, s[48:51], s82 offen lds
    s_add_u32 m0, s78, 135168
    s_add_u32 s82, s86, 393216
    buffer_load_dwordx4 v2, s[48:51], s82 offen lds
    s_add_u32 m0, s79, 122880
    s_add_u32 s82, s85, 0
    buffer_load_dwordx4 v3, s[36:39], s82 offen lds
    s_add_u32 m0, s79, 124928
    s_add_u32 s82, s85, 18432
    buffer_load_dwordx4 v3, s[36:39], s82 offen lds
    s_add_u32 m0, s79, 126976
    s_add_u32 s82, s85, 36864
    buffer_load_dwordx4 v3, s[36:39], s82 offen lds
    s_add_u32 m0, s79, 129024
    s_add_u32 s82, s85, 55296
    buffer_load_dwordx4 v3, s[36:39], s82 offen lds
    s_add_u32 m0, s79, 131072
    s_add_u32 s82, s85, 73728
    buffer_load_dwordx4 v3, s[36:39], s82 offen lds
    s_add_u32 m0, s79, 133120
    s_add_u32 s82, s85, 92160
    buffer_load_dwordx4 v3, s[36:39], s82 offen lds
    s_add_u32 s84, s84, 1
    s_cmp_eq_u32 s84, 9
    s_cselect_b32 s84, 0, s84
    s_waitcnt vmcnt(10)
    s_barrier
    s_add_u32 m0, s91, 37008
    s_add_u32 s82, s80, 9216
    buffer_load_dwordx4 v10, s[40:43], s82 offen nt lds
    s_add_u32 m0, s91, 41120
    s_add_u32 s82, s80, 10240
    buffer_load_dwordx4 v10, s[40:43], s82 offen nt lds
    s_add_u32 m0, s91, 45232
    s_add_u32 s82, s80, 11264
    buffer_load_dwordx4 v10, s[40:43], s82 offen nt lds
    s_cmp_le_u32 s98, 0
    s_cselect_b32 s83, 1, 0
    s_mul_i32 s83, s83, 147456
    s_add_u32 s87, s83, 18432
    buffer_load_dwordx4 v[40:43], v26, s[52:55], s83 offen
    buffer_load_dwordx4 v[44:47], v27, s[52:55], s83 offen
    buffer_load_dwordx4 v[48:51], v28, s[52:55], s83 offen
    buffer_load_dwordx4 v[52:55], v29, s[52:55], s83 offen
    buffer_load_dwordx4 v[56:59], v30, s[52:55], s83 offen
    s_waitcnt vmcnt(8)
    s_barrier
    buffer_load_dwordx4 v[60:63], v26, s[52:55], s87 offen
    buffer_load_dwordx4 v[64:67], v27, s[52:55], s87 offen
    buffer_load_dwordx4 v[68:71], v28, s[52:55], s87 offen
    buffer_load_dwordx4 v[72:75], v29, s[52:55], s87 offen
    buffer_load_dwordx4 v[76:79], v30, s[52:55], s87 offen
    s_add_u32 m0, s92, 49344
    s_add_u32 s82, s80, 0
    buffer_load_dwordx4 v10, s[44:47], s82 offen nt lds
    s_add_u32 m0, s92, 53472
    s_add_u32 s82, s80, 1024
    buffer_load_dwordx4 v10, s[44:47], s82 offen nt lds
    s_add_u32 m0, s92, 57600
    s_add_u32 s82, s80, 2048
    buffer_load_dwordx4 v10, s[44:47], s82 offen nt lds
    s_add_u32 m0, s92, 61728
    s_add_u32 s82, s80, 3072
    buffer_load_dwordx4 v10, s[44:47], s82 offen nt lds
    s_add_u32 m0, s92, 65856
    s_add_u32 s82, s80, 4096
    buffer_load_dwordx4 v10, s[44:47], s82 offen nt lds
    s_add_u32 m0, s92, 69984
    s_add_u32 s82, s80, 5120
    buffer_load_dwordx4 v10, s[44:47], s82 offen nt lds
    s_waitcnt vmcnt(16)
    s_barrier
    s_add_u32 m0, s92, 74112
    s_add_u32 s82, s80, 6144
    buffer_load_dwordx4 v10, s[44:47], s82 offen nt lds
    s_add_u32 m0, s92, 78240
    s_add_u32 s82, s80, 7168
    buffer_load_dwordx4 v10, s[44:47], s82 offen nt lds
    s_add_u32 m0, s92, 82368
    s_add_u32 s82, s80, 8192
    buffer_load_dwordx4 v10, s[44:47], s82 offen nt lds
    s_add_u32 m0, s92, 86496
    s_add_u32 s82, s80, 9216
    buffer_load_dwordx4 v10, s[44:47], s82 offen nt lds
    s_add_u32 m0, s92, 90624
    s_add_u32 s82, s80, 10240
    buffer_load_dwordx4 v10, s[44:47], s82 offen nt lds
    s_add_u32 m0, s92, 94752
    s_add_u32 s82, s80, 11264
    buffer_load_dwordx4 v10, s[44:47], s82 offen nt lds
    s_mov_b32 s83, s98
    s_mul_i32 s83, s83, 147456
    s_add_u32 s82, s83, 0
    s_add_u32 m0, s93, 122880
    s_nop 0
    buffer_load_dwordx4 v26, s[52:55], s82 offen lds
    s_add_u32 m0, s93, 123904
    s_nop 0
    buffer_load_dwordx4 v27, s[52:55], s82 offen lds
    s_add_u32 m0, s93, 124928
    s_nop 0
    buffer_load_dwordx4 v28, s[52:55], s82 offen lds
    s_add_u32 m0, s93, 125952
    s_nop 0
    buffer_load_dwordx4 v29, s[52:55], s82 offen lds
    s_add_u32 m0, s93, 126976
    s_nop 0
    buffer_load_dwordx4 v30, s[52:55], s82 offen lds
    s_add_u32 s82, s83, 18432
    s_add_u32 m0, s93, 128000
    s_nop 0
    buffer_load_dwordx4 v26, s[52:55], s82 offen lds
    s_add_u32 m0, s93, 129024
    s_nop 0
    buffer_load_dwordx4 v27, s[52:55], s82 offen lds
    s_add_u32 m0, s93, 130048
    s_nop 0
    buffer_load_dwordx4 v28, s[52:55], s82 offen lds
    s_add_u32 m0, s93, 131072
    s_nop 0
    buffer_load_dwordx4 v29, s[52:55], s82 offen lds
    s_add_u32 m0, s93, 132096
    s_nop 0
    buffer_load_dwordx4 v30, s[52:55], s82 offen lds
    s_waitcnt vmcnt(10)
    s_branch L_join
L_cls2:
    s_waitcnt vmcnt(10)
    s_barrier
    s_lshl_b32 s85, s84, 7
    s_lshl_b32 s86, s84, 19
    s_add_u32 m0, s78, 122880
    s_add_u32 s82, s86, 0
    buffer_load_dwordx4 v2, s[48:51], s82 offen lds
    s_add_u32 m0, s78, 126976
    s_add_u32 s82, s86, 131072
    buffer_load_dwordx4 v2, s[48:51], s82 offen lds
    s_add_u32 m0, s78, 131072
    s_add_u32 s82, s86, 262144
    buffer_load_dwordx4 v2, s[48:51], s82 offen lds
    s_add_u32 m0, s78, 135168
    s_add_u32 s82, s86, 393216
    buffer_load_dwordx4 v2, s[48:51], s82 offen lds
    s_add_u32 m0, s79, 122880
    s_add_u32 s82, s85, 0
    buffer_load_dwordx4 v3, s[36:39], s82 offen lds
    s_add_u32 m0, s79, 124928
    s_add_u32 s82, s85, 18432
    buffer_load_dwordx4 v3, s[36:39], s82 offen lds
    s_add_u32 m0, s79, 126976
    s_add_u32 s82, s85, 36864
    buffer_load_dwordx4 v3, s[36:39], s82 offen lds
    s_add_u32 m0, s79, 129024
    s_add_u32 s82, s85, 55296
    buffer_load_dwordx4 v3, s[36:39], s82 offen lds
    s_add_u32 m0, s79, 131072
    s_add_u32 s82, s85, 73728
    buffer_load_dwordx4 v3, s[36:39], s82 offen lds
    s_add_u32 m0, s79, 133120
    s_add_u32 s82, s85, 92160
    buffer_load_dwordx4 v3, s[36:39], s82 offen lds
    s_add_u32 s84, s84, 1
    s_cmp_eq_u32 s84, 9
    s_cselect_b32 s84, 0, s84
    s_waitcnt vmcnt(10)
    s_barrier
    s_mov_b64 exec, 7
    global_load_dword v125, v[24:25], off
    s_mov_b64 exec, -1
    s_lshl_b32 s85, s84, 7
    s_lshl_b32 s86, s84, 19
    s_add_u32 m0, s78, 40960
    s_add_u32 s82, s86, 0
    buffer_load_dwordx4 v2, s[48:51], s82 offen lds
    s_add_u32 m0, s78, 45056
    s_add_u32 s82, s86, 131072
    buffer_load_dwordx4 v2, s[48:51], s82 offen lds
    s_add_u32 m0, s78, 49152
    s_add_u32 s82, s86, 262144
    buffer_load_dwordx4 v2, s[48:51], s82 offen lds
    s_add_u32 m0, s78, 53248
    s_add_u32 s82, s86, 393216
    buffer_load_dwordx4 v2, s[48:51], s82 offen lds
    s_add_u32 m0, s79, 40960
    s_add_u32 s82, s85, 0
    buffer_load_dwordx4 v3, s[36:39], s82 offen lds
    s_add_u32 m0, s79, 43008
    s_add_u32 s82, s85, 18432
    buffer_load_dwordx4 v3, s[36:39], s82 offen lds
    s_add_u32 m0, s79, 45056
    s_add_u32 s82, s85, 36864
    buffer_load_dwordx4 v3, s[36:39], s82 offen lds
    s_add_u32 m0, s79, 47104
    s_add_u32 s82, s85, 55296
    buffer_load_dwordx4 v3, s[36:39], s82 offen lds
    s_add_u32 m0, s79, 49152
    s_add_u32 s82, s85, 73728
    buffer_load_dwordx4 v3, s[36:39], s82 offen lds
    s_add_u32 m0, s79, 51200
    s_add_u32 s82, s85, 92160
    buffer_load_dwordx4 v3, s[36:39], s82 offen lds
    s_add_u32 s84, s84, 1
    s_cmp_eq_u32 s84, 9
    s_cselect_b32 s84, 0, s84
    s_waitcnt vmcnt(11)
    s_barrier
    s_add_u32 m0, s91, 0
    s_add_u32 s82, s80, 0
    buffer_load_dwordx4 v10, s[40:43], s82 offen nt lds
    s_add_u32 m0, s91, 4112
    s_add_u32 s82, s80, 1024
    buffer_load_dwordx4 v10, s[40:43], s82 offen nt lds
    s_add_u32 m0, s91, 8224
    s_add_u32 s82, s80, 2048
    buffer_load_dwordx4 v10, s[40:43], s82 offen nt lds
    s_add_u32 m0, s91, 12336
    s_add_u32 s82, s80, 3072
    buffer_load_dwordx4 v10, s[40:43], s82 offen nt lds
    s_add_u32 m0, s91, 16448
    s_add_u32 s82, s80, 4096
    buffer_load_dwordx4 v10, s[40:43], s82 offen nt lds
    s_add_u32 m0, s91, 20560
    s_add_u32 s82, s80, 5120
    buffer_load_dwordx4 v10, s[40:43], s82 offen nt lds
    s_add_u32 m0, s91, 24672
    s_add_u32 s82, s80, 6144
    buffer_load_dwordx4 v10, s[40:43], s82 offen nt lds
    s_add_u32 m0, s91, 28784
    s_add_u32 s82, s80, 7168
    buffer_load_dwordx4 v10, s[40:43], s82 offen nt lds
    s_add_u32 m0, s91, 32896
    s_add_u32 s82, s80, 8192
    buffer_load_dwordx4 v10, s[40:43], s82 offen nt lds
    s_mov_b32 exec_lo, -1
    s_mov_b32 exec_hi, 15
    s_add_u32 s82, s94, 18432
    buffer_load_dword v23, v22, s[52:55], s82 offen
    s_add_u32 s82, s94, 23040
    buffer_load_dword v23, v22, s[52:55], s82 offen
    s_mov_b64 exec, -1
    s_waitcnt vmcnt(11)
    s_barrier
    s_lshl_b32 s85, s84, 7
    s_lshl_b32 s86, s84, 19
    s_add_u32 m0, s78, 81920
    s_add_u32 s82, s86, 0
    buffer_load_dwordx4 v2, s[48:51], s82 offen lds
    s_add_u32 m0, s78, 86016
    s_add_u32 s82, s86, 131072
    buffer_load_dwordx4 v2, s[48:51], s82 offen lds
    s_add_u32 m0, s78, 90112
    s_add_u32 s82, s86, 262144
    buffer_load_dwordx4 v2, s[48:51], s82 offen lds
    s_add_u32 m0, s78, 94208
    s_add_u32 s82, s86, 393216
    buffer_load_dwordx4 v2, s[48:51], s82 offen lds
    s_add_u32 m0, s79, 81920
    s_add_u32 s82, s85, 0
    buffer_load_dwordx4 v3, s[36:39], s82 offen lds
    s_add_u32 m0, s79, 83968
    s_add_u32 s82, s85, 18432
    buffer_load_dwordx4 v3, s[36:39], s82 offen lds
    s_add_u32 m0, s79, 86016
    s_add_u32 s82, s85, 36864
    buffer_load_dwordx4 v3, s[36:39], s82 offen lds
    s_add_u32 m0, s79, 88064
    s_add_u32 s82, s85, 55296
    buffer_load_dwordx4 v3, s[36:39], s82 offen lds
    s_add_u32 m0, s79, 90112
    s_add_u32 s82, s85, 73728
    buffer_load_dwordx4 v3, s[36:39], s82 offen lds
    s_add_u32 m0, s79, 92160
    s_add_u32 s82, s85, 92160
    buffer_load_dwordx4 v3, s[36:39], s82 offen lds
    s_add_u32 s84, s84, 1
    s_cmp_eq_u32 s84, 9
    s_cselect_b32 s84, 0, s84
    s_lshl_b32 s85, s84, 7
    s_lshl_b32 s86, s84, 19
    s_add_u32 m0, s78, 122880
    s_add_u32 s82, s86, 0
    buffer_load_dwordx4 v2, s[48:51], s82 offen lds
    s_add_u32 m0, s78, 126976
    s_add_u32 s82, s86, 131072
    buffer_load_dwordx4 v2, s[48:51], s82 offen lds
    s_add_u32 m0, s78, 131072
    s_add_u32 s82, s86, 262144
    buffer_load_dwordx4 v2, s[48:51], s82 offen lds
    s_add_u32 m0, s78, 135168
    s_add_u32 s82, s86, 393216
    buffer_load_dwordx4 v2, s[48:51], s82 offen lds
    s_add_u32 m0, s79, 122880
    s_add_u32 s82, s85, 0
    buffer_load_dwordx4 v3, s[36:39], s82 offen lds
    s_add_u32 m0, s79, 124928
    s_add_u32 s82, s85, 18432
    buffer_load_dwordx4 v3, s[36:39], s82 offen lds
    s_add_u32 m0, s79, 126976
    s_add_u32 s82, s85, 36864
    buffer_load_dwordx4 v3, s[36:39], s82 offen lds
    s_add_u32 m0, s79, 129024
    s_add_u32 s82, s85, 55296
    buffer_load_dwordx4 v3, s[36:39], s82 offen lds
    s_add_u32 m0, s79, 131072
    s_add_u32 s82, s85, 73728
    buffer_load_dwordx4 v3, s[36:39], s82 offen lds
    s_add_u32 m0, s79, 133120
    s_add_u32 s82, s85, 92160
    buffer_load_dwordx4 v3, s[36:39], s82 offen lds
    s_add_u32 s84, s84, 1
    s_cmp_eq_u32 s84, 9
    s_cselect_b32 s84, 0, s84
    s_waitcnt vmcnt(10)
    s_barrier
    s_add_u32 m0, s91, 37008
    s_add_u32 s82, s80, 9216
    buffer_load_dwordx4 v10, s[40:43], s82 offen nt lds
    s_add_u32 m0, s91, 41120
    s_add_u32 s82, s80, 10240
    buffer_load_dwordx4 v10, s[40:43], s82 offen nt lds
    s_add_u32 m0, s91, 45232
    s_add_u32 s82, s80, 11264
    buffer_load_dwordx4 v10, s[40:43], s82 offen nt lds
    s_cmp_le_u32 s98, 0
    s_cselect_b32 s83, 1, 0
    s_mul_i32 s83, s83, 147456
    s_add_u32 s87, s83, 18432
    buffer_load_dwordx4 v[40:43], v26, s[52:55], s83 offen
    buffer_load_dwordx4 v[44:47], v27, s[52:55], s83 offen
    buffer_load_dwordx4 v[48:51], v28, s[52:55], s83 offen
    buffer_load_dwordx4 v[52:55], v29, s[52:55], s83 offen
    buffer_load_dwordx4 v[56:59], v30, s[52:55], s83 offen
    s_waitcnt vmcnt(8)
    s_barrier
    buffer_load_dwordx4 v[60:63], v26, s[52:55], s87 offen
    buffer_load_dwordx4 v[64:67], v27, s[52:55], s87 offen
    buffer_load_dwordx4 v[68:71], v28, s[52:55], s87 offen
    buffer_load_dwordx4 v[72:75], v29, s[52:55], s87 offen
    buffer_load_dwordx4 v[76:79], v30, s[52:55], s87 offen
    s_add_u32 m0, s92, 49344
    s_add_u32 s82, s80, 0
    buffer_load_dwordx4 v10, s[44:47], s82 offen nt lds
    s_add_u32 m0, s92, 53472
    s_add_u32 s82, s80, 1024
    buffer_load_dwordx4 v10, s[44:47], s82 offen nt lds
    s_add_u32 m0, s92, 57600
    s_add_u32 s82, s80, 2048
    buffer_load_dwordx4 v10, s[44:47], s82 offen nt lds
    s_add_u32 m0, s92, 61728
    s_add_u32 s82, s80, 3072
    buffer_load_dwordx4 v10, s[44:47], s82 offen nt lds
    s_add_u32 m0, s92, 65856
    s_add_u32 s82, s80, 4096
    buffer_load_dwordx4 v10, s[44:47], s82 offen nt lds
    s_add_u32 m0, s92, 69984
    s_add_u32 s82, s80, 5120
    buffer_load_dwordx4 v10, s[44:47], s82 offen nt lds
    s_waitcnt vmcnt(16)
    s_barrier
    s_add_u32 m0, s92, 74112
    s_add_u32 s82, s80, 6144
    buffer_load_dwordx4 v10, s[44:47], s82 offen nt lds
    s_add_u32 m0, s92, 78240
    s_add_u32 s82, s80, 7168
    buffer_load_dwordx4 v10, s[44:47], s82 offen nt lds
    s_add_u32 m0, s92, 82368
    s_add_u32 s82, s80, 8192
    buffer_load_dwordx4 v10, s[44:47], s82 offen nt lds
    s_add_u32 m0, s92, 86496
    s_add_u32 s82, s80, 9216
    buffer_load_dwordx4 v10, s[44:47], s82 offen nt lds
    s_add_u32 m0, s92, 90624
    s_add_u32 s82, s80, 10240
    buffer_load_dwordx4 v10, s[44:47], s82 offen nt lds
    s_add_u32 m0, s92, 94752
    s_add_u32 s82, s80, 11264
    buffer_load_dwordx4 v10, s[44:47], s82 offen nt lds
    s_mov_b32 s83, s98
    s_mul_i32 s83, s83, 147456
    s_add_u32 s82, s83, 0
    s_add_u32 m0, s93, 122880
    s_nop 0
    buffer_load_dwordx4 v26, s[52:55], s82 offen lds
    s_add_u32 m0, s93, 123904
    s_nop 0
    buffer_load_dwordx4 v27, s[52:55], s82 offen lds
    s_add_u32 m0, s93, 124928
    s_nop 0
    buffer_load_dwordx4 v28, s[52:55], s82 offen lds
    s_add_u32 m0, s93, 125952
    s_nop 0
    buffer_load_dwordx4 v29, s[52:55], s82 offen lds
    s_add_u32 m0, s93, 126976
    s_nop 0
    buffer_load_dwordx4 v30, s[52:55], s82 offen lds
    s_add_u32 s82, s83, 18432
    s_add_u32 m0, s93, 128000
    s_nop 0
    buffer_load_dwordx4 v26, s[52:55], s82 offen lds
    s_add_u32 m0, s93, 129024
    s_nop 0
    buffer_load_dwordx4 v27, s[52:55], s82 offen lds
    s_add_u32 m0, s93, 130048
    s_nop 0
    buffer_load_dwordx4 v28, s[52:55], s82 offen lds
    s_add_u32 m0, s93, 131072
    s_nop 0
    buffer_load_dwordx4 v29, s[52:55], s82 offen lds
    s_add_u32 m0, s93, 132096
    s_nop 0
    buffer_load_dwordx4 v30, s[52:55], s82 offen lds
    s_waitcnt vmcnt(10)
    s_branch L_join
L_cls3:
    s_waitcnt vmcnt(10)
    s_barrier
    s_lshl_b32 s85, s84, 7
    s_lshl_b32 s86, s84, 19
    s_add_u32 m0, s78, 122880
    s_add_u32 s82, s86, 0
    buffer_load_dwordx4 v2, s[48:51], s82 offen lds
    s_add_u32 m0, s78, 126976
    s_add_u32 s82, s86, 131072
    buffer_load_dwordx4 v2, s[48:51], s82 offen lds
    s_add_u32 m0, s78, 131072
    s_add_u32 s82, s86, 262144
    buffer_load_dwordx4 v2, s[48:51], s82 offen lds
    s_add_u32 m0, s78, 135168
    s_add_u32 s82, s86, 393216
    buffer_load_dwordx4 v2, s[48:51], s82 offen lds
    s_add_u32 m0, s79, 122880
    s_add_u32 s82, s85, 0
    buffer_load_dwordx4 v3, s[36:39], s82 offen lds
    s_add_u32 m0, s79, 124928
    s_add_u32 s82, s85, 18432
    buffer_load_dwordx4 v3, s[36:39], s82 offen lds
    s_add_u32 m0, s79, 126976
    s_add_u32 s82, s85, 36864
    buffer_load_dwordx4 v3, s[36:39], s82 offen lds
    s_add_u32 m0, s79, 129024
    s_add_u32 s82, s85, 55296
    buffer_load_dwordx4 v3, s[36:39], s82 offen lds
    s_add_u32 m0, s79, 131072
    s_add_u32 s82, s85, 73728
    buffer_load_dwordx4 v3, s[36:39], s82 offen lds
    s_add_u32 m0, s79, 133120
    s_add_u32 s82, s85, 92160
    buffer_load_dwordx4 v3, s[36:39], s82 offen lds
    s_add_u32 s84, s84, 1
    s_cmp_eq_u32 s84, 9
    s_cselect_b32 s84, 0, s84
    s_waitcnt vmcnt(10)
    s_barrier
    s_mov_b64 exec, 7
    global_load_dword v125, v[24:25], off
    s_mov_b64 exec, -1
    s_lshl_b32 s85, s84, 7
    s_lshl_b32 s86, s84, 19
    s_add_u32 m0, s78, 40960
    s_add_u32 s82, s86, 0
    buffer_load_dwordx4 v2, s[48:51], s82 offen lds
    s_add_u32 m0, s78, 45056
    s_add_u32 s82, s86, 131072
    buffer_load_dwordx4 v2, s[48:51], s82 offen lds
    s_add_u32 m0, s78, 49152
    s_add_u32 s82, s86, 262144
    buffer_load_dwordx4 v2, s[48:51], s82 offen lds
    s_add_u32 m0, s78, 53248
    s_add_u32 s82, s86, 393216
    buffer_load_dwordx4 v2, s[48:51], s82 offen lds
    s_add_u32 m0, s79, 40960
    s_add_u32 s82, s85, 0
    buffer_load_dwordx4 v3, s[36:39], s82 offen lds
    s_add_u32 m0, s79, 43008
    s_add_u32 s82, s85, 18432
    buffer_load_dwordx4 v3, s[36:39], s82 offen lds
    s_add_u32 m0, s79, 45056
    s_add_u32 s82, s85, 36864
    buffer_load_dwordx4 v3, s[36:39], s82 offen lds
    s_add_u32 m0, s79, 47104
    s_add_u32 s82, s85, 55296
    buffer_load_dwordx4 v3, s[36:39], s82 offen lds
    s_add_u32 m0, s79, 49152
    s_add_u32 s82, s85, 73728
    buffer_load_dwordx4 v3, s[36:39], s82 offen lds
    s_add_u32 m0, s79, 51200
    s_add_u32 s82, s85, 92160
    buffer_load_dwordx4 v3, s[36:39], s82 offen lds
    s_add_u32 s84, s84, 1
    s_cmp_eq_u32 s84, 9
    s_cselect_b32 s84, 0, s84
    s_waitcnt vmcnt(11)
    s_barrier
    s_lshl_b32 s85, s84, 7
    s_lshl_b32 s86, s84, 19
    s_add_u32 m0, s78, 81920
    s_add_u32 s82, s86, 0
    buffer_load_dwordx4 v2, s[48:51], s82 offen lds
    s_add_u32 m0, s78, 86016
    s_add_u32 s82, s86, 131072
    buffer_load_dwordx4 v2, s[48:51], s82 offen lds
    s_add_u32 m0, s78, 90112
    s_add_u32 s82, s86, 262144
    buffer_load_dwordx4 v2, s[48:51], s82 offen lds
    s_add_u32 m0, s78, 94208
    s_add_u32 s82, s86, 393216
    buffer_load_dwordx4 v2, s[48:51], s82 offen lds
    s_add_u32 m0, s79, 81920
    s_add_u32 s82, s85, 0
    buffer_load_dwordx4 v3, s[36:39], s82 offen lds
    s_add_u32 m0, s79, 83968
    s_add_u32 s82, s85, 18432
    buffer_load_dwordx4 v3, s[36:39], s82 offen lds
    s_add_u32 m0, s79, 86016
    s_add_u32 s82, s85, 36864
    buffer_load_dwordx4 v3, s[36:39], s82 offen lds
    s_add_u32 m0, s79, 88064
    s_add_u32 s82, s85, 55296
    buffer_load_dwordx4 v3, s[36:39], s82 offen lds
    s_add_u32 m0, s79, 90112
    s_add_u32 s82, s85, 73728
    buffer_load_dwordx4 v3, s[36:39], s82 offen lds
    s_add_u32 m0, s79, 92160
    s_add_u32 s82, s85, 92160
    buffer_load_dwordx4 v3, s[36:39], s82 offen lds
    s_add_u32 s84, s84, 1
    s_cmp_eq_u32 s84, 9
    s_cselect_b32 s84, 0, s84
    s_waitcnt vmcnt(10)
    s_barrier
    s_lshl_b32 s85, s84, 7
    s_lshl_b32 s86, s84, 19
    s_add_u32 m0, s78, 122880
    s_add_u32 s82, s86, 0
    buffer_load_dwordx4 v2, s[48:51], s82 offen lds
    s_add_u32 m0, s78, 126976
    s_add_u32 s82, s86, 131072
    buffer_load_dwordx4 v2, s[48:51], s82 offen lds
    s_add_u32 m0, s78, 131072
    s_add_u32 s82, s86, 262144
    buffer_load_dwordx4 v2, s[48:51], s82 offen lds
    s_add_u32 m0, s78, 135168
    s_add_u32 s82, s86, 393216
    buffer_load_dwordx4 v2, s[48:51], s82 offen lds
    s_add_u32 m0, s79, 122880
    s_add_u32 s82, s85, 0
    buffer_load_dwordx4 v3, s[36:39], s82 offen lds
    s_add_u32 m0, s79, 124928
    s_add_u32 s82, s85, 18432
    buffer_load_dwordx4 v3, s[36:39], s82 offen lds
    s_add_u32 m0, s79, 126976
    s_add_u32 s82, s85, 36864
    buffer_load_dwordx4 v3, s[36:39], s82 offen lds
    s_add_u32 m0, s79, 129024
    s_add_u32 s82, s85, 55296
    buffer_load_dwordx4 v3, s[36:39], s82 offen lds
    s_add_u32 m0, s79, 131072
    s_add_u32 s82, s85, 73728
    buffer_load_dwordx4 v3, s[36:39], s82 offen lds
    s_add_u32 m0, s79, 133120
    s_add_u32 s82, s85, 92160
    buffer_load_dwordx4 v3, s[36:39], s82 offen lds
    s_add_u32 s84, s84, 1
    s_cmp_eq_u32 s84, 9
    s_cselect_b32 s84, 0, s84
    s_add_u32 m0, s91, 0
    s_add_u32 s82, s80, 0
    buffer_load_dwordx4 v10, s[40:43], s82 offen nt lds
    s_add_u32 m0, s91, 4112
    s_add_u32 s82, s80, 1024
    buffer_load_dwordx4 v10, s[40:43], s82 offen nt lds
    s_add_u32 m0, s91, 8224
    s_add_u32 s82, s80, 2048
    buffer_load_dwordx4 v10, s[40:43], s82 offen nt lds
    s_add_u32 m0, s91, 12336
    s_add_u32 s82, s80, 3072
    buffer_load_dwordx4 v10, s[40:43], s82 offen nt lds
    s_add_u32 m0, s91, 16448
    s_add_u32 s82, s80, 4096
    buffer_load_dwordx4 v10, s[40:43], s82 offen nt lds
    s_add_u32 m0, s91, 20560
    s_add_u32 s82, s80, 5120
    buffer_load_dwordx4 v10, s[40:43], s82 offen nt lds
    s_add_u32 m0, s91, 24672
    s_add_u32 s82, s80, 6144
    buffer_load_dwordx4 v10, s[40:43], s82 offen nt lds
    s_add_u32 m0, s91, 28784
    s_add_u32 s82, s80, 7168
    buffer_load_dwordx4 v10, s[40:43], s82 offen nt lds
    s_add_u32 m0, s91, 32896
    s_add_u32 s82, s80, 8192
    buffer_load_dwordx4 v10, s[40:43], s82 offen nt lds
    s_mov_b32 exec_lo, -1
    s_mov_b32 exec_hi, 15
    s_add_u32 s82, s94, 27648
    buffer_load_dword v23, v22, s[52:55], s82 offen
    s_add_u32 s82, s94, 32256
    buffer_load_dword v23, v22, s[52:55], s82 offen
    s_mov_b64 exec, -1
    s_waitcnt vmcnt(21)
    s_barrier
    s_add_u32 m0, s91, 37008
    s_add_u32 s82, s80, 9216
    buffer_load_dwordx4 v10, s[40:43], s82 offen nt lds
    s_add_u32 m0, s91, 41120
    s_add_u32 s82, s80, 10240
    buffer_load_dwordx4 v10, s[40:43], s82 offen nt lds
    s_add_u32 m0, s91, 45232
    s_add_u32 s82, s80, 11264
    buffer_load_dwordx4 v10, s[40:43], s82 offen nt lds
    s_add_u32 m0, s92, 49344
    s_add_u32 s82, s80, 0
    buffer_load_dwordx4 v10, s[44:47], s82 offen nt lds
    s_add_u32 m0, s92, 53472
    s_add_u32 s82, s80, 1024
    buffer_load_dwordx4 v10, s[44:47], s82 offen nt lds
    s_add_u32 m0, s92, 57600
    s_add_u32 s82, s80, 2048
    buffer_load_dwordx4 v10, s[44:47], s82 offen nt lds
    s_add_u32 m0, s92, 61728
    s_add_u32 s82, s80, 3072
    buffer_load_dwordx4 v10, s[44:47], s82 offen nt lds
    s_waitcnt vmcnt(7)
    s_barrier
    s_add_u32 m0, s92, 65856
    s_add_u32 s82, s80, 4096
    buffer_load_dwordx4 v10, s[44:47], s82 offen nt lds
    s_add_u32 m0, s92, 69984
    s_add_u32 s82, s80, 5120
    buffer_load_dwordx4 v10, s[44:47], s82 offen nt lds
    s_add_u32 m0, s92, 74112
    s_add_u32 s82, s80, 6144
    buffer_load_dwordx4 v10, s[44:47], s82 offen nt lds
    s_add_u32 m0, s92, 78240
    s_add_u32 s82, s80, 7168
    buffer_load_dwordx4 v10, s[44:47], s82 offen nt lds
    s_add_u32 m0, s92, 82368
    s_add_u32 s82, s80, 8192
    buffer_load_dwordx4 v10, s[44:47], s82 offen nt lds
    s_add_u32 m0, s92, 86496
    s_add_u32 s82, s80, 9216
    buffer_load_dwordx4 v10, s[44:47], s82 offen nt lds
    s_add_u32 m0, s92, 90624
    s_add_u32 s82, s80, 10240
    buffer_load_dwordx4 v10, s[44:47], s82 offen nt lds
    s_add_u32 m0, s92, 94752
    s_add_u32 s82, s80, 11264
    buffer_load_dwordx4 v10, s[44:47], s82 offen nt lds
    s_waitcnt vmcnt(12)
    s_barrier
    s_mov_b32 s83, s98
    s_mul_i32 s83, s83, 147456
    s_add_u32 s82, s83, 0
    s_add_u32 m0, s93, 122880
    s_nop 0
    buffer_load_dwordx4 v26, s[52:55], s82 offen lds
    s_add_u32 m0, s93, 123904
    s_nop 0
    buffer_load_dwordx4 v27, s[52:55], s82 offen lds
    s_add_u32 m0, s93, 124928
    s_nop 0
    buffer_load_dwordx4 v28, s[52:55], s82 offen lds
    s_add_u32 m0, s93, 125952
    s_nop 0
    buffer_load_dwordx4 v29, s[52:55], s82 offen lds
    s_add_u32 m0, s93, 126976
    s_nop 0
    buffer_load_dwordx4 v30, s[52:55], s82 offen lds
    s_add_u32 s82, s83, 18432
    s_add_u32 m0, s93, 128000
    s_nop 0
    buffer_load_dwordx4 v26, s[52:55], s82 offen lds
    s_add_u32 m0, s93, 129024
    s_nop 0
    buffer_load_dwordx4 v27, s[52:55], s82 offen lds
    s_add_u32 m0, s93, 130048
    s_nop 0
    buffer_load_dwordx4 v28, s[52:55], s82 offen lds
    s_add_u32 m0, s93, 131072
    s_nop 0
    buffer_load_dwordx4 v29, s[52:55], s82 offen lds
    s_add_u32 m0, s93, 132096
    s_nop 0
    buffer_load_dwordx4 v30, s[52:55], s82 offen lds
    s_cmp_le_u32 s98, 0
    s_cselect_b32 s83, 1, 0
    s_mul_i32 s83, s83, 147456
    s_add_u32 s87, s83, 18432
    buffer_load_dwordx4 v[40:43], v26, s[52:55], s83 offen
    buffer_load_dwordx4 v[44:47], v27, s[52:55], s83 offen
    buffer_load_dwordx4 v[48:51], v28, s[52:55], s83 offen
    buffer_load_dwordx4 v[52:55], v29, s[52:55], s83 offen
    buffer_load_dwordx4 v[56:59], v30, s[52:55], s83 offen
    buffer_load_dwordx4 v[60:63], v26, s[52:55], s87 offen
    buffer_load_dwordx4 v[64:67], v27, s[52:55], s87 offen
    buffer_load_dwordx4 v[68:71], v28, s[52:55], s87 offen
    buffer_load_dwordx4 v[72:75], v29, s[52:55], s87 offen
    buffer_load_dwordx4 v[76:79], v30, s[52:55], s87 offen
    s_waitcnt vmcnt(20)
L_join:
    s_barrier
    s_waitcnt vmcnt(0)
    ds_write_b128 v20, v[40:43]
    ds_write_b128 v20, v[44:47] offset:1024
    ds_write_b128 v20, v[48:51] offset:2048
    ds_write_b128 v20, v[52:55] offset:3072
    ds_write_b128 v20, v[56:59] offset:4096
    ds_write_b128 v20, v[60:63] offset:5120
    ds_write_b128 v20, v[64:67] offset:6144
    ds_write_b128 v20, v[68:71] offset:7168
    ds_write_b128 v20, v[72:75] offset:8192
    ds_write_b128 v20, v[76:79] offset:9216
    s_barrier
    s_mov_b64 exec, 7
    global_load_dword v125, v[24:25], off
    s_mov_b64 exec, -1
    s_barrier
    s_cmp_le_u32 s98, 1
    s_cselect_b32 s83, 2, 1
    s_mul_i32 s83, s83, 147456
    s_add_u32 s82, s83, 0
    s_add_u32 m0, s93, 40960
    s_nop 0
    buffer_load_dwordx4 v26, s[52:55], s82 offen lds
    s_add_u32 m0, s93, 41984
    s_nop 0
    buffer_load_dwordx4 v27, s[52:55], s82 offen lds
    s_add_u32 m0, s93, 43008
    s_nop 0
    buffer_load_dwordx4 v28, s[52:55], s82 offen lds
    s_add_u32 m0, s93, 44032
    s_nop 0
    buffer_load_dwordx4 v29, s[52:55], s82 offen lds
    s_add_u32 m0, s93, 45056
    s_nop 0
    buffer_load_dwordx4 v30, s[52:55], s82 offen lds
    s_add_u32 s82, s83, 18432
    s_add_u32 m0, s93, 46080
    s_nop 0
    buffer_load_dwordx4 v26, s[52:55], s82 offen lds
    s_add_u32 m0, s93, 47104
    s_nop 0
    buffer_load_dwordx4 v27, s[52:55], s82 offen lds
    s_add_u32 m0, s93, 48128
    s_nop 0
    buffer_load_dwordx4 v28, s[52:55], s82 offen lds
    s_add_u32 m0, s93, 49152
    s_nop 0
    buffer_load_dwordx4 v29, s[52:55], s82 offen lds
    s_add_u32 m0, s93, 50176
    s_nop 0
    buffer_load_dwordx4 v30, s[52:55], s82 offen lds
    s_waitcnt lgkmcnt(0)
    s_barrier
    s_cmp_le_u32 s98, 2
    s_cselect_b32 s83, 3, 2
    s_mul_i32 s83, s83, 147456
    s_add_u32 s82, s83, 0
    s_add_u32 m0, s93, 81920
    s_nop 0
    buffer_load_dwordx4 v26, s[52:55], s82 offen lds
    s_add_u32 m0, s93, 82944
    s_nop 0
    buffer_load_dwordx4 v27, s[52:55], s82 offen lds
    s_add_u32 m0, s93, 83968
    s_nop 0
    buffer_load_dwordx4 v28, s[52:55], s82 offen lds
    s_add_u32 m0, s93, 84992
    s_nop 0
    buffer_load_dwordx4 v29, s[52:55], s82 offen lds
    s_add_u32 m0, s93, 86016
    s_nop 0
    buffer_load_dwordx4 v30, s[52:55], s82 offen lds
    s_add_u32 s82, s83, 18432
    s_add_u32 m0, s93, 87040
    s_nop 0
    buffer_load_dwordx4 v26, s[52:55], s82 offen lds
    s_add_u32 m0, s93, 88064
    s_nop 0
    buffer_load_dwordx4 v27, s[52:55], s82 offen lds
    s_add_u32 m0, s93, 89088
    s_nop 0
    buffer_load_dwordx4 v28, s[52:55], s82 offen lds
    s_add_u32 m0, s93, 90112
    s_nop 0
    buffer_load_dwordx4 v29, s[52:55], s82 offen lds
    s_add_u32 m0, s93, 91136
    s_nop 0
    buffer_load_dwordx4 v30, s[52:55], s82 offen lds
    s_waitcnt vmcnt(10)
    s_barrier
    buffer_load_dwordx4 v[32:35], v16, s[64:67], 0 offen sc1
    s_mov_b64 exec, 7
    global_load_dword v125, v[24:25], off
    s_mov_b64 exec, -1
    s_waitcnt vmcnt(2)
    s_barrier
    v_lshlrev_b32 v14, 4, v1
    v_lshlrev_b32 v11, 3, v1
    s_lshr_b32 s90, s70, 2
    s_lshl_b32 s76, s69, 1
    s_add_u32 s90, s90, s76
    s_add_u32 s89, s90, 8
    s_lshl_b32 s91, s68, 2
    s_add_u32 s91, s91, s71
    s_lshl_b32 s91, s91, 2
    s_add_u32 s91, s91, s98
    s_lshl_b32 s91, s91, 2
    s_add_u32 s91, s91, s73
    s_lshr_b32 s76, s91, 3
    s_lshl_b32 s76, s76, 14
    s_and_b32 s77, s91, 7
    s_lshl_b32 s77, s77, 10
    s_add_u32 s76, s76, s77
    s_add_u32 s96, s76, 68157440
    s_lshl_b32 s92, s91, 18
    s_add_u32 s92, s92, 33554432
    s_lshr_b32 s76, s92, 8
    s_and_b32 s76, s76, 8192
    s_or_b32 s92, s92, s76
    s_lshl_b32 s76, s89, 14
    s_add_u32 s88, s92, s76
    s_lshl_b32 s76, s90, 10
    s_add_u32 s92, s92, s76
    s_mul_i32 s76, s89, 43
    s_lshr_b32 s76, s76, 7
    s_mul_i32 s77, s76, 3
    s_sub_u32 s77, s89, s77
    s_cmp_eq_u32 s89, 13
    s_cselect_b32 s77, 2, s77
    s_lshl_b32 s87, s76, 6
    s_mul_i32 s77, s77, 36864
    s_add_u32 s87, s87, s77
    s_lshl_b32 s77, s71, 2
    s_add_u32 s77, s77, s73
    s_mul_i32 s77, s77, 110592
    s_add_u32 s87, s87, s77
    s_mul_i32 s77, s68, 1152
    s_add_u32 s87, s87, s77
    s_mul_i32 s77, s98, 288
    s_add_u32 s87, s87, s77
    s_cmp_lt_u32 s89, 12
    s_cselect_b32 s77, 32, -256
    s_bitcmp1_b32 s98, 0
    s_cselect_b32 s77, s77, 0
    s_add_u32 s87, s87, s77
    s_cmp_lt_u32 s89, 12
    s_cselect_b32 s74, 32, 36864
    s_cmp_lt_u32 s89, 13
    s_cselect_b32 s78, -1, 0x33333333
    s_mov_b32 s79, s78
    s_mov_b32 s77, 0
    s_waitcnt vmcnt(1)
    v_readfirstlane_b32 s76, v32
    v_readfirstlane_b32 s75, v34
    v_readfirstlane_b32 s3, v35
Lnsp_4:
    s_cmp_lg_u32 s76, 0
    s_cselect_b32 s76, s75, 0
    s_cmp_ge_u32 s3, 524288
    s_cselect_b32 s76, s76, 0
    s_cmp_ge_u32 s76, 536870912
    s_cbranch_scc1 Lnok_3
    s_add_u32 s77, s77, 1
    s_cmp_gt_u32 s77, 131072
    s_cbranch_scc1 Lnok_3
    buffer_load_dwordx4 v[32:35], v16, s[64:67], 0 offen sc1
    s_waitcnt vmcnt(0)
    v_readfirstlane_b32 s76, v32
    v_readfirstlane_b32 s75, v34
    v_readfirstlane_b32 s3, v35
    s_nop 0
    s_branch Lnsp_4
Lnok_3:
    v_mov_b32 v8, v32
    v_mov_b32 v9, v33
    s_cmp_gt_u32 s76, 537001952
    s_cselect_b32 s76, 0xff, 0
    s_xor_b32 s75, s3, s76
    s_and_b32 s76, s2, 4
    s_lshr_b32 s75, s75, s76
    s_lshr_b32 s76, s75, s69
    s_and_b32 s76, s76, 1
    s_lshl_b32 s76, s76, 13
    s_xor_b32 s88, s88, s76
    s_add_u32 s96, s96, s76
    s_lshl_b32 s76, s90, 7
    s_add_u32 s96, s96, s76
    s_lshl_b32 s97, 1, s90
    s_xor_b32 s97, s97, 0xff
    v_lshrrev_b32 v4, 2, v1
    v_mul_u32_u24 v4, 2304, v4
    v_bfe_u32 v5, v1, 1, 1
    v_mad_u32_u24 v4, v5, s74, v4
    v_and_b32 v5, 1, v1
    v_lshl_add_u32 v4, v5, 4, v4
    v_lshlrev_b32 v3, 7, v1
    v_lshlrev_b32 v2, 4, v1
    v_lshl_add_u32 v2, s73, 10, v2
    v_add_u32 v2, 126976, v2
    s_barrier
    s_branch L_tail
L_compute:
    s_setprio 3
    s_and_b32 s43, s2, 0x98
    s_or_b32 s43, s43, s72
    s_cmp_lg_u32 s43, 0
    s_cbranch_scc1 L_np1
    s_memrealtime s[52:53]
    s_getreg_b32 s54, hwreg(HW_REG_XCC_ID, 2, 1)
    s_lshr_b32 s46, s2, 6
    s_lshl_b32 s46, s46, 3
    s_and_b32 s47, s2, 7
    s_add_u32 s46, s46, s47
    s_mul_i32 s46, s46, 448
    s_and_b32 s47, s2, 32
    s_lshl_b32 s47, s47, 8
    s_add_u32 s46, s46, s47
    s_add_u32 s46, s46, 71303168
    s_waitcnt lgkmcnt(0)
    s_add_u32 s44, s32, s46
    s_addc_u32 s45, s33, 0
    s_and_b32 s55, s52, 0x7f
    s_lshl_b32 s55, s55, 14
    s_memtime s[48:49]
    s_load_dword s46, s[44:45], s55
    s_waitcnt lgkmcnt(0)
    s_memtime s[50:51]
    s_waitcnt lgkmcnt(0)
    s_sub_u32 s50, s50, s48
    s_min_u32 s50, s50, 4095
    s_sub_u32 s51, 0, s50
    s_lshr_b32 s47, s47, 13
    s_cmp_eq_u32 s47, s54
    s_cselect_b32 s50, s50, s51
    s_add_u32 s50, s50, 16781311
    s_lshl_b32 s51, s54, s2
    s_add_u32 s51, s51, 65536
    s_cmp_lt_u32 s2, 8
    s_cselect_b32 s51, s51, 0
L_np1:
    v_lshrrev_b32 v160, 4, v1
    v_bfe_u32 v161, v1, 2, 2
    v_and_b32 v162, 3, v1
    v_and_b32 v163, 15, v1
    v_and_b32 v165, 1, v160
    s_mul_i32 s76, s72, 1024
    s_mul_i32 s77, s99, 81920
    s_add_u32 s76, s76, s77
    v_mul_u32_u24 v164, 4112, v161
    v_lshl_add_u32 v164, v162, 8, v164
    v_lshl_add_u32 v164, v160, 3, v164
    v_add_u32 v164, s76, v164
    v_xor_b32 v167, 0, v162
    v_lshl_add_u32 v252, v167, 6, v164
    v_xor_b32 v167, 1, v162
    v_lshl_add_u32 v253, v167, 6, v164
    v_xor_b32 v167, 2, v162
    v_lshl_add_u32 v254, v167, 6, v164
    v_xor_b32 v167, 3, v162
    v_lshl_add_u32 v255, v167, 6, v164
    v_lshl_add_u32 v164, v160, 3, v161
    v_lshlrev_b32 v164, 8, v164
    v_lshl_or_b32 v166, v165, 2, v161
    v_lshl_add_u32 v164, v166, 5, v164
    v_lshl_add_u32 v164, v162, 3, v164
    v_add_u32 v216, 40960, v164
    v_xor_b32 v217, 32, v216
    v_xor_b32 v218, 64, v216
    v_xor_b32 v219, 96, v216
    v_xor_b32 v220, 128, v216
    v_xor_b32 v221, 160, v216
    v_xor_b32 v222, 192, v216
    v_xor_b32 v223, 224, v216
    v_lshrrev_b32 v164, 1, v163
    v_xor_b32 v164, v164, v160
    v_lshlrev_b32 v164, 4, v164
    v_lshl_add_u32 v164, v163, 7, v164
    s_mul_i32 s76, s72, 6144
    s_add_u32 s76, s76, 57344
    v_add_u32 v224, s76, v164
    v_xor_b32 v225, 64, v224
    v_add_u32 v226, 81920, v216
    v_add_u32 v227, 81920, v217
    v_add_u32 v228, 81920, v218
    v_add_u32 v229, 81920, v219
    v_add_u32 v230, 81920, v220
    v_add_u32 v231, 81920, v221
    v_add_u32 v232, 81920, v222
    v_add_u32 v233, 81920, v223
    v_add_u32 v234, 81920, v224
    v_add_u32 v235, 81920, v225
    s_mul_i32 s76, s72, 1024
    s_cmp_eq_u32 s99, 1
    s_cselect_b32 s77, 0, 49344
    s_add_u32 s76, s76, s77
    v_mul_u32_u24 v164, 4128, v160
    v_lshl_add_u32 v164, v161, 8, v164
    v_lshl_add_u32 v164, v162, 3, v164
    v_add_u32 v164, s76, v164
    v_xor_b32 v167, 0, v161
    v_lshl_add_u32 v2, v167, 6, v164
    v_xor_b32 v167, 1, v161
    v_lshl_add_u32 v3, v167, 6, v164
    v_xor_b32 v167, 2, v161
    v_lshl_add_u32 v4, v167, 6, v164
    v_xor_b32 v167, 3, v161
    v_lshl_add_u32 v5, v167, 6, v164
    v_lshl_add_u32 v164, v160, 2, v161
    v_mul_u32_u24 v164, 320, v164
    v_lshl_add_u32 v164, v162, 3, v164
    s_cmp_eq_u32 s99, 1
    s_mov_b32 s76, 122880
    s_cselect_b32 s76, 81920, s76
    s_mov_b32 s93, 40960
    s_cselect_b32 s93, s93, 4294844416
    s_mov_b32 s94, 40960
    s_cselect_b32 s94, 4294844416, s94
    s_mov_b32 s95, 40960
    v_add_u32 v164, s76, v164
    s_and_b32 s77, s98, 1
    s_cselect_b32 s76, 1, 8
    v_xor_b32 v167, s76, v165
    v_lshl_add_u32 v12, v167, 5, v164
    s_lshl_b32 s77, s77, 6
    v_add_u32 v164, s77, v164
    v_lshl_add_u32 v13, v165, 5, v164
    v_xor_b32 v167, 1, v165
    v_lshl_add_u32 v15, v167, 5, v164
    v_lshlrev_b32 v14, 4, v1
    v_lshlrev_b32 v11, 3, v1
    v_mov_b32 v10, 0
    s_lshl_b32 s81, s69, 3
    s_and_b32 s82, s70, 4
    s_add_u32 s81, s81, s82
    s_lshl_b32 s76, s68, 2
    s_add_u32 s76, s76, s71
    s_lshl_b32 s76, s76, 2
    s_add_u32 s76, s76, s72
    s_lshl_b32 s76, s76, 5
    s_add_u32 s76, s76, s81
    s_lshl_b32 s80, s76, 15
    s_lshr_b32 s76, s80, 8
    s_and_b32 s76, s76, 8192
    s_or_b32 s80, s80, s76
    s_and_b32 s76, s72, 1
    s_lshl_b32 s40, s76, 12
    s_and_b32 s76, s72, 2
    s_lshl_b32 s76, s76, 13
    s_or_b32 s40, s40, s76
    s_xor_b32 s41, s40, 4096
    s_xor_b32 s42, s40, 16384
    s_mov_b32 s83, 1040356334
    s_and_b32 s76, s2, 7
    s_lshr_b32 s77, s2, 5
    s_lshl_b32 s77, s77, 3
    s_or_b32 s76, s76, s77
    s_lshl_b32 s76, s76, 2
    s_add_u32 s76, s76, s72
    s_lshr_b32 s77, s76, 6
    s_lshl_b32 s77, s77, 14
    s_and_b32 s76, s76, 63
    s_lshl_b32 s76, s76, 7
    s_add_u32 s76, s76, s77
    s_add_u32 s84, s76, 67108864
    s_lshl_b32 s85, 1, s98
    s_xor_b32 s86, s85, 15
    s_lshr_b32 s90, s70, 2
    s_lshl_b32 s76, s69, 1
    s_add_u32 s90, s90, s76
    s_add_u32 s89, s90, 0
    s_lshl_b32 s91, s68, 2
    s_add_u32 s91, s91, s71
    s_lshl_b32 s91, s91, 2
    s_add_u32 s91, s91, s98
    s_lshl_b32 s91, s91, 2
    s_add_u32 s91, s91, s72
    s_lshr_b32 s76, s91, 3
    s_lshl_b32 s76, s76, 14
    s_and_b32 s77, s91, 7
    s_lshl_b32 s77, s77, 10
    s_add_u32 s76, s76, s77
    s_add_u32 s96, s76, 68157440
    s_lshl_b32 s92, s91, 18
    s_add_u32 s92, s92, 33554432
    s_lshr_b32 s76, s92, 8
    s_and_b32 s76, s76, 8192
    s_or_b32 s92, s92, s76
    s_lshl_b32 s76, s89, 14
    s_add_u32 s88, s92, s76
    s_lshl_b32 s76, s90, 10
    s_add_u32 s92, s92, s76
    s_mul_i32 s76, s89, 43
    s_lshr_b32 s76, s76, 7
    s_mul_i32 s77, s76, 3
    s_sub_u32 s77, s89, s77
    s_cmp_eq_u32 s89, 13
    s_cselect_b32 s77, 2, s77
    s_lshl_b32 s87, s76, 6
    s_mul_i32 s77, s77, 36864
    s_add_u32 s87, s87, s77
    s_lshl_b32 s77, s71, 2
    s_add_u32 s77, s77, s72
    s_mul_i32 s77, s77, 110592
    s_add_u32 s87, s87, s77
    s_mul_i32 s77, s68, 1152
    s_add_u32 s87, s87, s77
    s_mul_i32 s77, s98, 288
    s_add_u32 s87, s87, s77
    s_cmp_lt_u32 s89, 12
    s_cselect_b32 s77, 32, -256
    s_bitcmp1_b32 s98, 0
    s_cselect_b32 s77, s77, 0
    s_add_u32 s87, s87, s77
    s_cmp_lt_u32 s89, 12
    s_cselect_b32 s74, 32, 36864
    s_cmp_lt_u32 s89, 13
    s_cselect_b32 s78, -1, 0x33333333
    s_mov_b32 s79, s78
    s_lshl_b32 s97, 1, s90
    s_waitcnt lgkmcnt(0)
    s_cmp_eq_u32 s68, 0
    s_mov_b32 s56, s28
    s_mov_b32 s57, s29
    s_mov_b32 s58, 1769472
    s_mov_b32 s59, 0x20000
    s_mov_b32 s64, s30
    s_mov_b32 s65, s31
    s_mov_b32 s66, 256
    s_mov_b32 s67, 0x20000
    s_mov_b32 s60, s32
    s_mov_b32 s61, s33
    s_mov_b32 s62, 83886080
    s_mov_b32 s63, 0x20000
    s_mov_b32 s36, s32
    s_mov_b32 s37, s33
    s_mov_b32 s38, 0
    s_mov_b32 s39, 0x20000
    v_mov_b32 v7, s84
    s_xor_b32 s76, s84, 8192
    v_writelane_b32 v7, s76, 1
    s_lshl_b32 s76, s90, 7
    s_add_u32 s76, s76, s96
    v_writelane_b32 v7, s76, 2
    s_xor_b32 s76, s76, 8192
    v_writelane_b32 v7, s76, 3
    s_mov_b64 exec, 15
    buffer_load_dword v6, v7, s[60:63], 0 offen sc1
    s_mov_b64 exec, -1
    s_cmp_lg_u32 s43, 0
    s_cbranch_scc1 L_np2
    v_mov_b32 v112, s50
    v_mov_b32 v113, s51
    s_mov_b64 exec, 1
    buffer_atomic_add_x2 v[112:113], v10, s[64:67], 0 offen offset:8 sc1
    s_mov_b64 exec, -1
    s_nop 1
L_np2:
    s_barrier
    ds_read_b128 v[144:147], v224
    ds_read_b128 v[148:151], v224 offset:2048
    ds_read_b128 v[152:155], v224 offset:4096
    ds_read_b64_tr_b16 v[112:113], v216
    ds_read_b64_tr_b16 v[114:115], v216 offset:1024
    ds_read_b64_tr_b16 v[116:117], v217
    ds_read_b64_tr_b16 v[118:119], v217 offset:1024
    ds_read_b64_tr_b16 v[120:121], v218
    ds_read_b64_tr_b16 v[122:123], v218 offset:1024
    ds_read_b64_tr_b16 v[124:125], v219
    ds_read_b64_tr_b16 v[126:127], v219 offset:1024
    ds_read_b64_tr_b16 v[128:129], v220
    ds_read_b64_tr_b16 v[130:131], v220 offset:1024
    ds_read_b64_tr_b16 v[132:133], v221
    ds_read_b64_tr_b16 v[134:135], v221 offset:1024
    ds_read_b64_tr_b16 v[136:137], v222
    ds_read_b64_tr_b16 v[138:139], v222 offset:1024
    ds_read_b64_tr_b16 v[140:141], v223
    ds_read_b64_tr_b16 v[142:143], v223 offset:1024
    s_waitcnt lgkmcnt(8)
    v_mfma_f32_16x16x32_bf16 v[16:19], v[112:115], v[144:147], 0
    ds_read_b128 v[156:159], v225
    ds_read_b128 v[160:163], v225 offset:2048
    v_mfma_f32_16x16x32_bf16 v[20:23], v[112:115], v[148:151], 0
    ds_read_b128 v[164:167], v225 offset:4096
    v_mfma_f32_16x16x32_bf16 v[24:27], v[112:115], v[152:155], 0
    s_waitcnt lgkmcnt(0)
    v_mfma_f32_16x16x32_bf16 v[36:39], v[116:119], v[152:155], 0
    ds_read_b64_tr_b16 v[112:113], v216 offset:8192
    v_mfma_f32_16x16x32_bf16 v[32:35], v[116:119], v[148:151], 0
    ds_read_b64_tr_b16 v[114:115], v216 offset:9216
    v_mfma_f32_16x16x32_bf16 v[28:31], v[116:119], v[144:147], 0
    s_waitcnt lgkmcnt(0)
    v_mfma_f32_16x16x32_bf16 v[40:43], v[120:123], v[144:147], 0
    ds_read_b64_tr_b16 v[116:117], v217 offset:8192
    v_mfma_f32_16x16x32_bf16 v[44:47], v[120:123], v[148:151], 0
    ds_read_b64_tr_b16 v[118:119], v217 offset:9216
    v_mfma_f32_16x16x32_bf16 v[48:51], v[120:123], v[152:155], 0
    s_waitcnt lgkmcnt(0)
    v_mfma_f32_16x16x32_bf16 v[60:63], v[124:127], v[152:155], 0
    ds_read_b64_tr_b16 v[120:121], v218 offset:8192
    v_mfma_f32_16x16x32_bf16 v[56:59], v[124:127], v[148:151], 0
    ds_read_b64_tr_b16 v[122:123], v218 offset:9216
    v_mfma_f32_16x16x32_bf16 v[52:55], v[124:127], v[144:147], 0
    s_waitcnt lgkmcnt(0)
    v_mfma_f32_16x16x32_bf16 v[64:67], v[128:131], v[144:147], 0
    ds_read_b64_tr_b16 v[124:125], v219 offset:8192
    v_mfma_f32_16x16x32_bf16 v[68:71], v[128:131], v[148:151], 0
    ds_read_b64_tr_b16 v[126:127], v219 offset:9216
    v_mfma_f32_16x16x32_bf16 v[72:75], v[128:131], v[152:155], 0
    s_waitcnt lgkmcnt(0)
    v_mfma_f32_16x16x32_bf16 v[84:87], v[132:135], v[152:155], 0
    ds_read_b64_tr_b16 v[128:129], v220 offset:8192
    v_mfma_f32_16x16x32_bf16 v[80:83], v[132:135], v[148:151], 0
    ds_read_b64_tr_b16 v[130:131], v220 offset:9216
    v_mfma_f32_16x16x32_bf16 v[76:79], v[132:135], v[144:147], 0
    s_waitcnt lgkmcnt(0)
    v_mfma_f32_16x16x32_bf16 v[88:91], v[136:139], v[144:147], 0
    ds_read_b64_tr_b16 v[132:133], v221 offset:8192
    v_mfma_f32_16x16x32_bf16 v[92:95], v[136:139], v[148:151], 0
    ds_read_b64_tr_b16 v[134:135], v221 offset:9216
    v_mfma_f32_16x16x32_bf16 v[96:99], v[136:139], v[152:155], 0
    s_waitcnt lgkmcnt(0)
    v_mfma_f32_16x16x32_bf16 v[108:111], v[140:143], v[152:155], 0
    ds_read_b64_tr_b16 v[136:137], v222 offset:8192
    v_mfma_f32_16x16x32_bf16 v[104:107], v[140:143], v[148:151], 0
    ds_read_b64_tr_b16 v[138:139], v222 offset:9216
    v_mfma_f32_16x16x32_bf16 v[100:103], v[140:143], v[144:147], 0
    s_waitcnt lgkmcnt(0)
    v_mfma_f32_16x16x32_bf16 v[16:19], v[112:115], v[156:159], v[16:19]
    ds_read_b64_tr_b16 v[140:141], v223 offset:8192
    v_mfma_f32_16x16x32_bf16 v[20:23], v[112:115], v[160:163], v[20:23]
    ds_read_b64_tr_b16 v[142:143], v223 offset:9216
    v_mfma_f32_16x16x32_bf16 v[24:27], v[112:115], v[164:167], v[24:27]
    s_waitcnt lgkmcnt(0)
    v_mfma_f32_16x16x32_bf16 v[36:39], v[116:119], v[164:167], v[36:39]
    v_mfma_f32_16x16x32_bf16 v[32:35], v[116:119], v[160:163], v[32:35]
    v_mfma_f32_16x16x32_bf16 v[28:31], v[116:119], v[156:159], v[28:31]
    s_waitcnt lgkmcnt(0)
    v_mfma_f32_16x16x32_bf16 v[40:43], v[120:123], v[156:159], v[40:43]
    v_mfma_f32_16x16x32_bf16 v[44:47], v[120:123], v[160:163], v[44:47]
    v_mfma_f32_16x16x32_bf16 v[48:51], v[120:123], v[164:167], v[48:51]
    s_waitcnt lgkmcnt(0)
    s_barrier
    v_mfma_f32_16x16x32_bf16 v[60:63], v[124:127], v[164:167], v[60:63]
    ds_read_b128 v[144:147], v224 offset:40960
    ds_read_b64_tr_b16 v[112:113], v216 offset:40960
    v_mfma_f32_16x16x32_bf16 v[56:59], v[124:127], v[160:163], v[56:59]
    ds_read_b64_tr_b16 v[114:115], v216 offset:41984
    ds_read_b128 v[148:151], v224 offset:43008
    v_mfma_f32_16x16x32_bf16 v[52:55], v[124:127], v[156:159], v[52:55]
    ds_read_b128 v[152:155], v224 offset:45056
    ds_read_b64_tr_b16 v[116:117], v217 offset:40960
    s_waitcnt lgkmcnt(0)
    v_mfma_f32_16x16x32_bf16 v[64:67], v[128:131], v[156:159], v[64:67]
    ds_read_b64_tr_b16 v[118:119], v217 offset:41984
    ds_read_b64_tr_b16 v[120:121], v218 offset:40960
    v_mfma_f32_16x16x32_bf16 v[68:71], v[128:131], v[160:163], v[68:71]
    ds_read_b64_tr_b16 v[122:123], v218 offset:41984
    ds_read_b64_tr_b16 v[124:125], v219 offset:40960
    v_mfma_f32_16x16x32_bf16 v[72:75], v[128:131], v[164:167], v[72:75]
    ds_read_b64_tr_b16 v[126:127], v219 offset:41984
    s_waitcnt lgkmcnt(0)
    v_mfma_f32_16x16x32_bf16 v[84:87], v[132:135], v[164:167], v[84:87]
    ds_read_b64_tr_b16 v[128:129], v220 offset:40960
    v_mfma_f32_16x16x32_bf16 v[80:83], v[132:135], v[160:163], v[80:83]
    ds_read_b64_tr_b16 v[130:131], v220 offset:41984
    v_mfma_f32_16x16x32_bf16 v[76:79], v[132:135], v[156:159], v[76:79]
    s_waitcnt lgkmcnt(0)
    v_mfma_f32_16x16x32_bf16 v[88:91], v[136:139], v[156:159], v[88:91]
    ds_read_b64_tr_b16 v[132:133], v221 offset:40960
    v_mfma_f32_16x16x32_bf16 v[92:95], v[136:139], v[160:163], v[92:95]
    ds_read_b64_tr_b16 v[134:135], v221 offset:41984
    v_mfma_f32_16x16x32_bf16 v[96:99], v[136:139], v[164:167], v[96:99]
    s_waitcnt lgkmcnt(0)
    v_mfma_f32_16x16x32_bf16 v[108:111], v[140:143], v[164:167], v[108:111]
    ds_read_b64_tr_b16 v[136:137], v222 offset:40960
    v_mfma_f32_16x16x32_bf16 v[104:107], v[140:143], v[160:163], v[104:107]
    ds_read_b64_tr_b16 v[138:139], v222 offset:41984
    v_mfma_f32_16x16x32_bf16 v[100:103], v[140:143], v[156:159], v[100:103]
    s_waitcnt lgkmcnt(0)
    v_mfma_f32_16x16x32_bf16 v[16:19], v[112:115], v[144:147], v[16:19]
    ds_read_b64_tr_b16 v[140:141], v223 offset:40960
    ds_read_b64_tr_b16 v[142:143], v223 offset:41984
    v_mfma_f32_16x16x32_bf16 v[20:23], v[112:115], v[148:151], v[20:23]
    ds_read_b128 v[156:159], v225 offset:40960
    ds_read_b128 v[160:163], v225 offset:43008
    v_mfma_f32_16x16x32_bf16 v[24:27], v[112:115], v[152:155], v[24:27]
    ds_read_b128 v[164:167], v225 offset:45056
    s_waitcnt lgkmcnt(0)
    v_mfma_f32_16x16x32_bf16 v[36:39], v[116:119], v[152:155], v[36:39]
    ds_read_b64_tr_b16 v[112:113], v216 offset:49152
    v_mfma_f32_16x16x32_bf16 v[32:35], v[116:119], v[148:151], v[32:35]
    ds_read_b64_tr_b16 v[114:115], v216 offset:50176
    v_mfma_f32_16x16x32_bf16 v[28:31], v[116:119], v[144:147], v[28:31]
    s_waitcnt lgkmcnt(0)
    v_mfma_f32_16x16x32_bf16 v[40:43], v[120:123], v[144:147], v[40:43]
    ds_read_b64_tr_b16 v[116:117], v217 offset:49152
    v_mfma_f32_16x16x32_bf16 v[44:47], v[120:123], v[148:151], v[44:47]
    ds_read_b64_tr_b16 v[118:119], v217 offset:50176
    v_mfma_f32_16x16x32_bf16 v[48:51], v[120:123], v[152:155], v[48:51]
    s_waitcnt lgkmcnt(0)
    v_mfma_f32_16x16x32_bf16 v[60:63], v[124:127], v[152:155], v[60:63]
    ds_read_b64_tr_b16 v[120:121], v218 offset:49152
    v_mfma_f32_16x16x32_bf16 v[56:59], v[124:127], v[148:151], v[56:59]
    ds_read_b64_tr_b16 v[122:123], v218 offset:50176
    v_mfma_f32_16x16x32_bf16 v[52:55], v[124:127], v[144:147], v[52:55]
    s_waitcnt lgkmcnt(0)
    v_mfma_f32_16x16x32_bf16 v[64:67], v[128:131], v[144:147], v[64:67]
    ds_read_b64_tr_b16 v[124:125], v219 offset:49152
    v_mfma_f32_16x16x32_bf16 v[68:71], v[128:131], v[148:151], v[68:71]
    ds_read_b64_tr_b16 v[126:127], v219 offset:50176
    v_mfma_f32_16x16x32_bf16 v[72:75], v[128:131], v[152:155], v[72:75]
    s_waitcnt lgkmcnt(0)
    v_mfma_f32_16x16x32_bf16 v[84:87], v[132:135], v[152:155], v[84:87]
    ds_read_b64_tr_b16 v[128:129], v220 offset:49152
    v_mfma_f32_16x16x32_bf16 v[80:83], v[132:135], v[148:151], v[80:83]
    ds_read_b64_tr_b16 v[130:131], v220 offset:50176
    v_mfma_f32_16x16x32_bf16 v[76:79], v[132:135], v[144:147], v[76:79]
    s_waitcnt lgkmcnt(0)
    v_mfma_f32_16x16x32_bf16 v[88:91], v[136:139], v[144:147], v[88:91]
    ds_read_b64_tr_b16 v[132:133], v221 offset:49152
    v_mfma_f32_16x16x32_bf16 v[92:95], v[136:139], v[148:151], v[92:95]
    ds_read_b64_tr_b16 v[134:135], v221 offset:50176
    v_mfma_f32_16x16x32_bf16 v[96:99], v[136:139], v[152:155], v[96:99]
    s_waitcnt lgkmcnt(0)
    v_mfma_f32_16x16x32_bf16 v[108:111], v[140:143], v[152:155], v[108:111]
    ds_read_b64_tr_b16 v[136:137], v222 offset:49152
    v_mfma_f32_16x16x32_bf16 v[104:107], v[140:143], v[148:151], v[104:107]
    ds_read_b64_tr_b16 v[138:139], v222 offset:50176
    v_mfma_f32_16x16x32_bf16 v[100:103], v[140:143], v[144:147], v[100:103]
    s_waitcnt lgkmcnt(0)
    v_mfma_f32_16x16x32_bf16 v[16:19], v[112:115], v[156:159], v[16:19]
    ds_read_b64_tr_b16 v[140:141], v223 offset:49152
    v_mfma_f32_16x16x32_bf16 v[20:23], v[112:115], v[160:163], v[20:23]
    ds_read_b64_tr_b16 v[142:143], v223 offset:50176
    v_mfma_f32_16x16x32_bf16 v[24:27], v[112:115], v[164:167], v[24:27]
    s_waitcnt lgkmcnt(0)
    v_mfma_f32_16x16x32_bf16 v[36:39], v[116:119], v[164:167], v[36:39]
    v_mfma_f32_16x16x32_bf16 v[32:35], v[116:119], v[160:163], v[32:35]
    v_mfma_f32_16x16x32_bf16 v[28:31], v[116:119], v[156:159], v[28:31]
    s_waitcnt lgkmcnt(0)
    v_mfma_f32_16x16x32_bf16 v[40:43], v[120:123], v[156:159], v[40:43]
    v_mfma_f32_16x16x32_bf16 v[44:47], v[120:123], v[160:163], v[44:47]
    v_mfma_f32_16x16x32_bf16 v[48:51], v[120:123], v[164:167], v[48:51]
    s_waitcnt lgkmcnt(0)
    s_barrier
    v_mfma_f32_16x16x32_bf16 v[60:63], v[124:127], v[164:167], v[60:63]
    ds_read_b128 v[144:147], v234
    ds_read_b64_tr_b16 v[112:113], v226
    v_mfma_f32_16x16x32_bf16 v[56:59], v[124:127], v[160:163], v[56:59]
    ds_read_b64_tr_b16 v[114:115], v226 offset:1024
    ds_read_b128 v[148:151], v234 offset:2048
    v_mfma_f32_16x16x32_bf16 v[52:55], v[124:127], v[156:159], v[52:55]
    ds_read_b128 v[152:155], v234 offset:4096
    ds_read_b64_tr_b16 v[116:117], v227
    s_waitcnt lgkmcnt(0)
    v_mfma_f32_16x16x32_bf16 v[64:67], v[128:131], v[156:159], v[64:67]
    ds_read_b64_tr_b16 v[118:119], v227 offset:1024
    ds_read_b64_tr_b16 v[120:121], v228
    v_mfma_f32_16x16x32_bf16 v[68:71], v[128:131], v[160:163], v[68:71]
    ds_read_b64_tr_b16 v[122:123], v228 offset:1024
    ds_read_b64_tr_b16 v[124:125], v229
    v_mfma_f32_16x16x32_bf16 v[72:75], v[128:131], v[164:167], v[72:75]
    ds_read_b64_tr_b16 v[126:127], v229 offset:1024
    s_waitcnt lgkmcnt(0)
    v_mfma_f32_16x16x32_bf16 v[84:87], v[132:135], v[164:167], v[84:87]
    ds_read_b64_tr_b16 v[128:129], v230
    v_mfma_f32_16x16x32_bf16 v[80:83], v[132:135], v[160:163], v[80:83]
    ds_read_b64_tr_b16 v[130:131], v230 offset:1024
    v_mfma_f32_16x16x32_bf16 v[76:79], v[132:135], v[156:159], v[76:79]
    s_waitcnt lgkmcnt(0)
    v_mfma_f32_16x16x32_bf16 v[88:91], v[136:139], v[156:159], v[88:91]
    ds_read_b64_tr_b16 v[132:133], v231
    v_mfma_f32_16x16x32_bf16 v[92:95], v[136:139], v[160:163], v[92:95]
    ds_read_b64_tr_b16 v[134:135], v231 offset:1024
    v_mfma_f32_16x16x32_bf16 v[96:99], v[136:139], v[164:167], v[96:99]
    s_waitcnt lgkmcnt(0)
    v_mfma_f32_16x16x32_bf16 v[108:111], v[140:143], v[164:167], v[108:111]
    ds_read_b64_tr_b16 v[136:137], v232
    v_mfma_f32_16x16x32_bf16 v[104:107], v[140:143], v[160:163], v[104:107]
    ds_read_b64_tr_b16 v[138:139], v232 offset:1024
    v_mfma_f32_16x16x32_bf16 v[100:103], v[140:143], v[156:159], v[100:103]
    s_waitcnt lgkmcnt(0)
    v_mfma_f32_16x16x32_bf16 v[16:19], v[112:115], v[144:147], v[16:19]
    ds_read_b64_tr_b16 v[140:141], v233
    ds_read_b64_tr_b16 v[142:143], v233 offset:1024
    v_mfma_f32_16x16x32_bf16 v[20:23], v[112:115], v[148:151], v[20:23]
    ds_read_b128 v[156:159], v235
    ds_read_b128 v[160:163], v235 offset:2048
    v_mfma_f32_16x16x32_bf16 v[24:27], v[112:115], v[152:155], v[24:27]
    ds_read_b128 v[164:167], v235 offset:4096
    s_waitcnt lgkmcnt(0)
    v_mfma_f32_16x16x32_bf16 v[36:39], v[116:119], v[152:155], v[36:39]
    ds_read_b64_tr_b16 v[112:113], v226 offset:8192
    v_mfma_f32_16x16x32_bf16 v[32:35], v[116:119], v[148:151], v[32:35]
    ds_read_b64_tr_b16 v[114:115], v226 offset:9216
    v_mfma_f32_16x16x32_bf16 v[28:31], v[116:119], v[144:147], v[28:31]
    s_waitcnt lgkmcnt(0)
    v_mfma_f32_16x16x32_bf16 v[40:43], v[120:123], v[144:147], v[40:43]
    ds_read_b64_tr_b16 v[116:117], v227 offset:8192
    v_mfma_f32_16x16x32_bf16 v[44:47], v[120:123], v[148:151], v[44:47]
    ds_read_b64_tr_b16 v[118:119], v227 offset:9216
    v_mfma_f32_16x16x32_bf16 v[48:51], v[120:123], v[152:155], v[48:51]
    s_waitcnt lgkmcnt(0)
    v_mfma_f32_16x16x32_bf16 v[60:63], v[124:127], v[152:155], v[60:63]
    ds_read_b64_tr_b16 v[120:121], v228 offset:8192
    v_mfma_f32_16x16x32_bf16 v[56:59], v[124:127], v[148:151], v[56:59]
    ds_read_b64_tr_b16 v[122:123], v228 offset:9216
    v_mfma_f32_16x16x32_bf16 v[52:55], v[124:127], v[144:147], v[52:55]
    s_waitcnt lgkmcnt(0)
    v_mfma_f32_16x16x32_bf16 v[64:67], v[128:131], v[144:147], v[64:67]
    ds_read_b64_tr_b16 v[124:125], v229 offset:8192
    v_mfma_f32_16x16x32_bf16 v[68:71], v[128:131], v[148:151], v[68:71]
    ds_read_b64_tr_b16 v[126:127], v229 offset:9216
    v_mfma_f32_16x16x32_bf16 v[72:75], v[128:131], v[152:155], v[72:75]
    s_waitcnt lgkmcnt(0)
    v_mfma_f32_16x16x32_bf16 v[84:87], v[132:135], v[152:155], v[84:87]
    ds_read_b64_tr_b16 v[128:129], v230 offset:8192
    v_mfma_f32_16x16x32_bf16 v[80:83], v[132:135], v[148:151], v[80:83]
    ds_read_b64_tr_b16 v[130:131], v230 offset:9216
    v_mfma_f32_16x16x32_bf16 v[76:79], v[132:135], v[144:147], v[76:79]
    s_waitcnt lgkmcnt(0)
    v_mfma_f32_16x16x32_bf16 v[88:91], v[136:139], v[144:147], v[88:91]
    ds_read_b64_tr_b16 v[132:133], v231 offset:8192
    v_mfma_f32_16x16x32_bf16 v[92:95], v[136:139], v[148:151], v[92:95]
    ds_read_b64_tr_b16 v[134:135], v231 offset:9216
    v_mfma_f32_16x16x32_bf16 v[96:99], v[136:139], v[152:155], v[96:99]
    s_waitcnt lgkmcnt(0)
    v_mfma_f32_16x16x32_bf16 v[108:111], v[140:143], v[152:155], v[108:111]
    ds_read_b64_tr_b16 v[136:137], v232 offset:8192
    v_mfma_f32_16x16x32_bf16 v[104:107], v[140:143], v[148:151], v[104:107]
    ds_read_b64_tr_b16 v[138:139], v232 offset:9216
    v_mfma_f32_16x16x32_bf16 v[100:103], v[140:143], v[144:147], v[100:103]
    s_waitcnt lgkmcnt(0)
    v_mfma_f32_16x16x32_bf16 v[16:19], v[112:115], v[156:159], v[16:19]
    ds_read_b64_tr_b16 v[140:141], v233 offset:8192
    v_mfma_f32_16x16x32_bf16 v[20:23], v[112:115], v[160:163], v[20:23]
    ds_read_b64_tr_b16 v[142:143], v233 offset:9216
    v_mfma_f32_16x16x32_bf16 v[24:27], v[112:115], v[164:167], v[24:27]
    s_waitcnt lgkmcnt(0)
    v_mfma_f32_16x16x32_bf16 v[36:39], v[116:119], v[164:167], v[36:39]
    v_mfma_f32_16x16x32_bf16 v[32:35], v[116:119], v[160:163], v[32:35]
    v_mfma_f32_16x16x32_bf16 v[28:31], v[116:119], v[156:159], v[28:31]
    s_waitcnt lgkmcnt(0)
    v_mfma_f32_16x16x32_bf16 v[40:43], v[120:123], v[156:159], v[40:43]
    v_mfma_f32_16x16x32_bf16 v[44:47], v[120:123], v[160:163], v[44:47]
    v_mfma_f32_16x16x32_bf16 v[48:51], v[120:123], v[164:167], v[48:51]
    s_waitcnt lgkmcnt(0)
    s_barrier
    v_mfma_f32_16x16x32_bf16 v[60:63], v[124:127], v[164:167], v[60:63]
    ds_read_b128 v[144:147], v224
    ds_read_b64_tr_b16 v[112:113], v216
    v_mfma_f32_16x16x32_bf16 v[56:59], v[124:127], v[160:163], v[56:59]
    ds_read_b64_tr_b16 v[114:115], v216 offset:1024
    ds_read_b128 v[148:151], v224 offset:2048
    v_mfma_f32_16x16x32_bf16 v[52:55], v[124:127], v[156:159], v[52:55]
    ds_read_b128 v[152:155], v224 offset:4096
    ds_read_b64_tr_b16 v[116:117], v217
    s_waitcnt lgkmcnt(0)
    v_mfma_f32_16x16x32_bf16 v[64:67], v[128:131], v[156:159], v[64:67]
    ds_read_b64_tr_b16 v[118:119], v217 offset:1024
    ds_read_b64_tr_b16 v[120:121], v218
    v_mfma_f32_16x16x32_bf16 v[68:71], v[128:131], v[160:163], v[68:71]
    ds_read_b64_tr_b16 v[122:123], v218 offset:1024
    ds_read_b64_tr_b16 v[124:125], v219
    v_mfma_f32_16x16x32_bf16 v[72:75], v[128:131], v[164:167], v[72:75]
    ds_read_b64_tr_b16 v[126:127], v219 offset:1024
    s_waitcnt lgkmcnt(0)
    v_mfma_f32_16x16x32_bf16 v[84:87], v[132:135], v[164:167], v[84:87]
    ds_read_b64_tr_b16 v[128:129], v220
    v_mfma_f32_16x16x32_bf16 v[80:83], v[132:135], v[160:163], v[80:83]
    ds_read_b64_tr_b16 v[130:131], v220 offset:1024
    v_mfma_f32_16x16x32_bf16 v[76:79], v[132:135], v[156:159], v[76:79]
    s_waitcnt lgkmcnt(0)
    v_mfma_f32_16x16x32_bf16 v[88:91], v[136:139], v[156:159], v[88:91]
    ds_read_b64_tr_b16 v[132:133], v221
    v_mfma_f32_16x16x32_bf16 v[92:95], v[136:139], v[160:163], v[92:95]
    ds_read_b64_tr_b16 v[134:135], v221 offset:1024
    v_mfma_f32_16x16x32_bf16 v[96:99], v[136:139], v[164:167], v[96:99]
    s_waitcnt lgkmcnt(0)
    v_mfma_f32_16x16x32_bf16 v[108:111], v[140:143], v[164:167], v[108:111]
    ds_read_b64_tr_b16 v[136:137], v222
    v_mfma_f32_16x16x32_bf16 v[104:107], v[140:143], v[160:163], v[104:107]
    ds_read_b64_tr_b16 v[138:139], v222 offset:1024
    v_mfma_f32_16x16x32_bf16 v[100:103], v[140:143], v[156:159], v[100:103]
    s_waitcnt lgkmcnt(0)
    v_mfma_f32_16x16x32_bf16 v[16:19], v[112:115], v[144:147], v[16:19]
    ds_read_b64_tr_b16 v[140:141], v223
    ds_read_b64_tr_b16 v[142:143], v223 offset:1024
    v_mfma_f32_16x16x32_bf16 v[20:23], v[112:115], v[148:151], v[20:23]
    ds_read_b128 v[156:159], v225
    ds_read_b128 v[160:163], v225 offset:2048
    v_mfma_f32_16x16x32_bf16 v[24:27], v[112:115], v[152:155], v[24:27]
    ds_read_b128 v[164:167], v225 offset:4096
    v_mfma_f32_16x16x32_bf16 v[36:39], v[116:119], v[152:155], v[36:39]
    ds_read_b64_tr_b16 v[112:113], v216 offset:8192
    v_mfma_f32_16x16x32_bf16 v[32:35], v[116:119], v[148:151], v[32:35]
    ds_read_b64_tr_b16 v[114:115], v216 offset:9216
    v_mfma_f32_16x16x32_bf16 v[28:31], v[116:119], v[144:147], v[28:31]
    v_mfma_f32_16x16x32_bf16 v[40:43], v[120:123], v[144:147], v[40:43]
    ds_read_b64_tr_b16 v[116:117], v217 offset:8192
    v_mfma_f32_16x16x32_bf16 v[44:47], v[120:123], v[148:151], v[44:47]
    ds_read_b64_tr_b16 v[118:119], v217 offset:9216
    v_mfma_f32_16x16x32_bf16 v[48:51], v[120:123], v[152:155], v[48:51]
    v_mfma_f32_16x16x32_bf16 v[60:63], v[124:127], v[152:155], v[60:63]
    ds_read_b64_tr_b16 v[120:121], v218 offset:8192
    v_mfma_f32_16x16x32_bf16 v[56:59], v[124:127], v[148:151], v[56:59]
    ds_read_b64_tr_b16 v[122:123], v218 offset:9216
    v_mfma_f32_16x16x32_bf16 v[52:55], v[124:127], v[144:147], v[52:55]
    v_mfma_f32_16x16x32_bf16 v[64:67], v[128:131], v[144:147], v[64:67]
    ds_read_b64_tr_b16 v[124:125], v219 offset:8192
    v_mfma_f32_16x16x32_bf16 v[68:71], v[128:131], v[148:151], v[68:71]
    ds_read_b64_tr_b16 v[126:127], v219 offset:9216
    v_mfma_f32_16x16x32_bf16 v[72:75], v[128:131], v[152:155], v[72:75]
    v_mfma_f32_16x16x32_bf16 v[84:87], v[132:135], v[152:155], v[84:87]
    ds_read_b64_tr_b16 v[128:129], v220 offset:8192
    v_mfma_f32_16x16x32_bf16 v[80:83], v[132:135], v[148:151], v[80:83]
    ds_read_b64_tr_b16 v[130:131], v220 offset:9216
    v_mfma_f32_16x16x32_bf16 v[76:79], v[132:135], v[144:147], v[76:79]
    v_mfma_f32_16x16x32_bf16 v[88:91], v[136:139], v[144:147], v[88:91]
    ds_read_b64_tr_b16 v[132:133], v221 offset:8192
    v_mfma_f32_16x16x32_bf16 v[92:95], v[136:139], v[148:151], v[92:95]
    ds_read_b64_tr_b16 v[134:135], v221 offset:9216
    v_mfma_f32_16x16x32_bf16 v[96:99], v[136:139], v[152:155], v[96:99]
    s_waitcnt lgkmcnt(8)
    v_mfma_f32_16x16x32_bf16 v[108:111], v[140:143], v[152:155], v[108:111]
    ds_read_b64_tr_b16 v[136:137], v222 offset:8192
    v_mfma_f32_16x16x32_bf16 v[104:107], v[140:143], v[148:151], v[104:107]
    ds_read_b64_tr_b16 v[138:139], v222 offset:9216
    v_mfma_f32_16x16x32_bf16 v[100:103], v[140:143], v[144:147], v[100:103]
    v_mfma_f32_16x16x32_bf16 v[16:19], v[112:115], v[156:159], v[16:19]
    ds_read_b64_tr_b16 v[140:141], v223 offset:8192
    v_mfma_f32_16x16x32_bf16 v[20:23], v[112:115], v[160:163], v[20:23]
    ds_read_b64_tr_b16 v[142:143], v223 offset:9216
    v_mfma_f32_16x16x32_bf16 v[24:27], v[112:115], v[164:167], v[24:27]
    v_mfma_f32_16x16x32_bf16 v[36:39], v[116:119], v[164:167], v[36:39]
    v_mfma_f32_16x16x32_bf16 v[32:35], v[116:119], v[160:163], v[32:35]
    v_mfma_f32_16x16x32_bf16 v[28:31], v[116:119], v[156:159], v[28:31]
    s_waitcnt lgkmcnt(8)
    v_mfma_f32_16x16x32_bf16 v[40:43], v[120:123], v[156:159], v[40:43]
    v_mfma_f32_16x16x32_bf16 v[44:47], v[120:123], v[160:163], v[44:47]
    v_mfma_f32_16x16x32_bf16 v[48:51], v[120:123], v[164:167], v[48:51]
    s_waitcnt lgkmcnt(0)
    s_barrier
    v_mfma_f32_16x16x32_bf16 v[60:63], v[124:127], v[164:167], v[60:63]
    ds_read_b128 v[144:147], v224 offset:40960
    ds_read_b64_tr_b16 v[112:113], v216 offset:40960
    v_mfma_f32_16x16x32_bf16 v[56:59], v[124:127], v[160:163], v[56:59]
    ds_read_b64_tr_b16 v[114:115], v216 offset:41984
    ds_read_b128 v[148:151], v224 offset:43008
    v_mfma_f32_16x16x32_bf16 v[52:55], v[124:127], v[156:159], v[52:55]
    ds_read_b128 v[152:155], v224 offset:45056
    ds_read_b64_tr_b16 v[116:117], v217 offset:40960
    v_mfma_f32_16x16x32_bf16 v[64:67], v[128:131], v[156:159], v[64:67]
    ds_read_b64_tr_b16 v[118:119], v217 offset:41984
    ds_read_b64_tr_b16 v[120:121], v218 offset:40960
    v_mfma_f32_16x16x32_bf16 v[68:71], v[128:131], v[160:163], v[68:71]
    ds_read_b64_tr_b16 v[122:123], v218 offset:41984
    ds_read_b64_tr_b16 v[124:125], v219 offset:40960
    v_mfma_f32_16x16x32_bf16 v[72:75], v[128:131], v[164:167], v[72:75]
    ds_read_b64_tr_b16 v[126:127], v219 offset:41984
    v_mfma_f32_16x16x32_bf16 v[84:87], v[132:135], v[164:167], v[84:87]
    ds_read_b64_tr_b16 v[128:129], v220 offset:40960
    v_mfma_f32_16x16x32_bf16 v[80:83], v[132:135], v[160:163], v[80:83]
    ds_read_b64_tr_b16 v[130:131], v220 offset:41984
    v_mfma_f32_16x16x32_bf16 v[76:79], v[132:135], v[156:159], v[76:79]
    v_mfma_f32_16x16x32_bf16 v[88:91], v[136:139], v[156:159], v[88:91]
    ds_read_b64_tr_b16 v[132:133], v221 offset:40960
    v_mfma_f32_16x16x32_bf16 v[92:95], v[136:139], v[160:163], v[92:95]
    ds_read_b64_tr_b16 v[134:135], v221 offset:41984
    v_mfma_f32_16x16x32_bf16 v[96:99], v[136:139], v[164:167], v[96:99]
    v_mfma_f32_16x16x32_bf16 v[108:111], v[140:143], v[164:167], v[108:111]
    ds_read_b64_tr_b16 v[136:137], v222 offset:40960
    v_mfma_f32_16x16x32_bf16 v[104:107], v[140:143], v[160:163], v[104:107]
    ds_read_b64_tr_b16 v[138:139], v222 offset:41984
    v_mfma_f32_16x16x32_bf16 v[100:103], v[140:143], v[156:159], v[100:103]
    s_waitcnt lgkmcnt(8)
    v_mfma_f32_16x16x32_bf16 v[16:19], v[112:115], v[144:147], v[16:19]
    ds_read_b64_tr_b16 v[140:141], v223 offset:40960
    ds_read_b64_tr_b16 v[142:143], v223 offset:41984
    v_mfma_f32_16x16x32_bf16 v[20:23], v[112:115], v[148:151], v[20:23]
    ds_read_b128 v[156:159], v225 offset:40960
    ds_read_b128 v[160:163], v225 offset:43008
    v_mfma_f32_16x16x32_bf16 v[24:27], v[112:115], v[152:155], v[24:27]
    ds_read_b128 v[164:167], v225 offset:45056
    v_mfma_f32_16x16x32_bf16 v[36:39], v[116:119], v[152:155], v[36:39]
    ds_read_b64_tr_b16 v[112:113], v216 offset:49152
    v_mfma_f32_16x16x32_bf16 v[32:35], v[116:119], v[148:151], v[32:35]
    ds_read_b64_tr_b16 v[114:115], v216 offset:50176
    v_mfma_f32_16x16x32_bf16 v[28:31], v[116:119], v[144:147], v[28:31]
    v_mfma_f32_16x16x32_bf16 v[40:43], v[120:123], v[144:147], v[40:43]
    ds_read_b64_tr_b16 v[116:117], v217 offset:49152
    v_mfma_f32_16x16x32_bf16 v[44:47], v[120:123], v[148:151], v[44:47]
    ds_read_b64_tr_b16 v[118:119], v217 offset:50176
    v_mfma_f32_16x16x32_bf16 v[48:51], v[120:123], v[152:155], v[48:51]
    s_waitcnt lgkmcnt(8)
    v_mfma_f32_16x16x32_bf16 v[60:63], v[124:127], v[152:155], v[60:63]
    ds_read_b64_tr_b16 v[120:121], v218 offset:49152
    v_mfma_f32_16x16x32_bf16 v[56:59], v[124:127], v[148:151], v[56:59]
    ds_read_b64_tr_b16 v[122:123], v218 offset:50176
    v_mfma_f32_16x16x32_bf16 v[52:55], v[124:127], v[144:147], v[52:55]
    v_mfma_f32_16x16x32_bf16 v[64:67], v[128:131], v[144:147], v[64:67]
    ds_read_b64_tr_b16 v[124:125], v219 offset:49152
    v_mfma_f32_16x16x32_bf16 v[68:71], v[128:131], v[148:151], v[68:71]
    ds_read_b64_tr_b16 v[126:127], v219 offset:50176
    v_mfma_f32_16x16x32_bf16 v[72:75], v[128:131], v[152:155], v[72:75]
    v_mfma_f32_16x16x32_bf16 v[84:87], v[132:135], v[152:155], v[84:87]
    ds_read_b64_tr_b16 v[128:129], v220 offset:49152
    v_mfma_f32_16x16x32_bf16 v[80:83], v[132:135], v[148:151], v[80:83]
    ds_read_b64_tr_b16 v[130:131], v220 offset:50176
    v_mfma_f32_16x16x32_bf16 v[76:79], v[132:135], v[144:147], v[76:79]
    v_mfma_f32_16x16x32_bf16 v[88:91], v[136:139], v[144:147], v[88:91]
    ds_read_b64_tr_b16 v[132:133], v221 offset:49152
    v_mfma_f32_16x16x32_bf16 v[92:95], v[136:139], v[148:151], v[92:95]
    ds_read_b64_tr_b16 v[134:135], v221 offset:50176
    v_mfma_f32_16x16x32_bf16 v[96:99], v[136:139], v[152:155], v[96:99]
    s_waitcnt lgkmcnt(8)
    v_mfma_f32_16x16x32_bf16 v[108:111], v[140:143], v[152:155], v[108:111]
    ds_read_b64_tr_b16 v[136:137], v222 offset:49152
    v_mfma_f32_16x16x32_bf16 v[104:107], v[140:143], v[148:151], v[104:107]
    ds_read_b64_tr_b16 v[138:139], v222 offset:50176
    v_mfma_f32_16x16x32_bf16 v[100:103], v[140:143], v[144:147], v[100:103]
    v_mfma_f32_16x16x32_bf16 v[16:19], v[112:115], v[156:159], v[16:19]
    ds_read_b64_tr_b16 v[140:141], v223 offset:49152
    v_mfma_f32_16x16x32_bf16 v[20:23], v[112:115], v[160:163], v[20:23]
    ds_read_b64_tr_b16 v[142:143], v223 offset:50176
    v_mfma_f32_16x16x32_bf16 v[24:27], v[112:115], v[164:167], v[24:27]
    v_mfma_f32_16x16x32_bf16 v[36:39], v[116:119], v[164:167], v[36:39]
    v_mfma_f32_16x16x32_bf16 v[32:35], v[116:119], v[160:163], v[32:35]
    v_mfma_f32_16x16x32_bf16 v[28:31], v[116:119], v[156:159], v[28:31]
    s_waitcnt lgkmcnt(8)
    v_mfma_f32_16x16x32_bf16 v[40:43], v[120:123], v[156:159], v[40:43]
    v_mfma_f32_16x16x32_bf16 v[44:47], v[120:123], v[160:163], v[44:47]
    v_mfma_f32_16x16x32_bf16 v[48:51], v[120:123], v[164:167], v[48:51]
    s_waitcnt lgkmcnt(0)
    s_barrier
    v_mfma_f32_16x16x32_bf16 v[60:63], v[124:127], v[164:167], v[60:63]
    ds_read_b128 v[144:147], v234
    ds_read_b64_tr_b16 v[112:113], v226
    v_mfma_f32_16x16x32_bf16 v[56:59], v[124:127], v[160:163], v[56:59]
    ds_read_b64_tr_b16 v[114:115], v226 offset:1024
    ds_read_b128 v[148:151], v234 offset:2048
    v_mfma_f32_16x16x32_bf16 v[52:55], v[124:127], v[156:159], v[52:55]
    ds_read_b128 v[152:155], v234 offset:4096
    ds_read_b64_tr_b16 v[116:117], v227
    v_mfma_f32_16x16x32_bf16 v[64:67], v[128:131], v[156:159], v[64:67]
    ds_read_b64_tr_b16 v[118:119], v227 offset:1024
    ds_read_b64_tr_b16 v[120:121], v228
    v_mfma_f32_16x16x32_bf16 v[68:71], v[128:131], v[160:163], v[68:71]
    ds_read_b64_tr_b16 v[122:123], v228 offset:1024
    ds_read_b64_tr_b16 v[124:125], v229
    v_mfma_f32_16x16x32_bf16 v[72:75], v[128:131], v[164:167], v[72:75]
    ds_read_b64_tr_b16 v[126:127], v229 offset:1024
    v_mfma_f32_16x16x32_bf16 v[84:87], v[132:135], v[164:167], v[84:87]
    ds_read_b64_tr_b16 v[128:129], v230
    v_mfma_f32_16x16x32_bf16 v[80:83], v[132:135], v[160:163], v[80:83]
    ds_read_b64_tr_b16 v[130:131], v230 offset:1024
    v_mfma_f32_16x16x32_bf16 v[76:79], v[132:135], v[156:159], v[76:79]
    v_mfma_f32_16x16x32_bf16 v[88:91], v[136:139], v[156:159], v[88:91]
    ds_read_b64_tr_b16 v[132:133], v231
    v_mfma_f32_16x16x32_bf16 v[92:95], v[136:139], v[160:163], v[92:95]
    ds_read_b64_tr_b16 v[134:135], v231 offset:1024
    v_mfma_f32_16x16x32_bf16 v[96:99], v[136:139], v[164:167], v[96:99]
    v_mfma_f32_16x16x32_bf16 v[108:111], v[140:143], v[164:167], v[108:111]
    ds_read_b64_tr_b16 v[136:137], v232
    v_mfma_f32_16x16x32_bf16 v[104:107], v[140:143], v[160:163], v[104:107]
    ds_read_b64_tr_b16 v[138:139], v232 offset:1024
    v_mfma_f32_16x16x32_bf16 v[100:103], v[140:143], v[156:159], v[100:103]
    s_waitcnt lgkmcnt(8)
    v_mfma_f32_16x16x32_bf16 v[16:19], v[112:115], v[144:147], v[16:19]
    ds_read_b64_tr_b16 v[140:141], v233
    ds_read_b64_tr_b16 v[142:143], v233 offset:1024
    v_mfma_f32_16x16x32_bf16 v[20:23], v[112:115], v[148:151], v[20:23]
    ds_read_b128 v[156:159], v235
    ds_read_b128 v[160:163], v235 offset:2048
    v_mfma_f32_16x16x32_bf16 v[24:27], v[112:115], v[152:155], v[24:27]
    ds_read_b128 v[164:167], v235 offset:4096
    v_mfma_f32_16x16x32_bf16 v[36:39], v[116:119], v[152:155], v[36:39]
    ds_read_b64_tr_b16 v[112:113], v226 offset:8192
    v_mfma_f32_16x16x32_bf16 v[32:35], v[116:119], v[148:151], v[32:35]
    ds_read_b64_tr_b16 v[114:115], v226 offset:9216
    v_mfma_f32_16x16x32_bf16 v[28:31], v[116:119], v[144:147], v[28:31]
    v_mfma_f32_16x16x32_bf16 v[40:43], v[120:123], v[144:147], v[40:43]
    ds_read_b64_tr_b16 v[116:117], v227 offset:8192
    v_mfma_f32_16x16x32_bf16 v[44:47], v[120:123], v[148:151], v[44:47]
    ds_read_b64_tr_b16 v[118:119], v227 offset:9216
    v_mfma_f32_16x16x32_bf16 v[48:51], v[120:123], v[152:155], v[48:51]
    s_waitcnt lgkmcnt(8)
    v_mfma_f32_16x16x32_bf16 v[60:63], v[124:127], v[152:155], v[60:63]
    ds_read_b64_tr_b16 v[120:121], v228 offset:8192
    v_mfma_f32_16x16x32_bf16 v[56:59], v[124:127], v[148:151], v[56:59]
    ds_read_b64_tr_b16 v[122:123], v228 offset:9216
    v_mfma_f32_16x16x32_bf16 v[52:55], v[124:127], v[144:147], v[52:55]
    v_mfma_f32_16x16x32_bf16 v[64:67], v[128:131], v[144:147], v[64:67]
    ds_read_b64_tr_b16 v[124:125], v229 offset:8192
    v_mfma_f32_16x16x32_bf16 v[68:71], v[128:131], v[148:151], v[68:71]
    ds_read_b64_tr_b16 v[126:127], v229 offset:9216
    v_mfma_f32_16x16x32_bf16 v[72:75], v[128:131], v[152:155], v[72:75]
    v_mfma_f32_16x16x32_bf16 v[84:87], v[132:135], v[152:155], v[84:87]
    ds_read_b64_tr_b16 v[128:129], v230 offset:8192
    v_mfma_f32_16x16x32_bf16 v[80:83], v[132:135], v[148:151], v[80:83]
    ds_read_b64_tr_b16 v[130:131], v230 offset:9216
    v_mfma_f32_16x16x32_bf16 v[76:79], v[132:135], v[144:147], v[76:79]
    v_mfma_f32_16x16x32_bf16 v[88:91], v[136:139], v[144:147], v[88:91]
    ds_read_b64_tr_b16 v[132:133], v231 offset:8192
    v_mfma_f32_16x16x32_bf16 v[92:95], v[136:139], v[148:151], v[92:95]
    ds_read_b64_tr_b16 v[134:135], v231 offset:9216
    v_mfma_f32_16x16x32_bf16 v[96:99], v[136:139], v[152:155], v[96:99]
    s_waitcnt lgkmcnt(8)
    v_mfma_f32_16x16x32_bf16 v[108:111], v[140:143], v[152:155], v[108:111]
    ds_read_b64_tr_b16 v[136:137], v232 offset:8192
    v_mfma_f32_16x16x32_bf16 v[104:107], v[140:143], v[148:151], v[104:107]
    ds_read_b64_tr_b16 v[138:139], v232 offset:9216
    v_mfma_f32_16x16x32_bf16 v[100:103], v[140:143], v[144:147], v[100:103]
    v_mfma_f32_16x16x32_bf16 v[16:19], v[112:115], v[156:159], v[16:19]
    ds_read_b64_tr_b16 v[140:141], v233 offset:8192
    v_mfma_f32_16x16x32_bf16 v[20:23], v[112:115], v[160:163], v[20:23]
    ds_read_b64_tr_b16 v[142:143], v233 offset:9216
    v_mfma_f32_16x16x32_bf16 v[24:27], v[112:115], v[164:167], v[24:27]
    v_mfma_f32_16x16x32_bf16 v[36:39], v[116:119], v[164:167], v[36:39]
    v_mfma_f32_16x16x32_bf16 v[32:35], v[116:119], v[160:163], v[32:35]
    v_mfma_f32_16x16x32_bf16 v[28:31], v[116:119], v[156:159], v[28:31]
    s_waitcnt lgkmcnt(8)
    v_mfma_f32_16x16x32_bf16 v[40:43], v[120:123], v[156:159], v[40:43]
    v_mfma_f32_16x16x32_bf16 v[44:47], v[120:123], v[160:163], v[44:47]
    v_mfma_f32_16x16x32_bf16 v[48:51], v[120:123], v[164:167], v[48:51]
    s_waitcnt lgkmcnt(0)
    s_barrier
    v_mfma_f32_16x16x32_bf16 v[60:63], v[124:127], v[164:167], v[60:63]
    ds_read_b128 v[144:147], v224
    ds_read_b64_tr_b16 v[112:113], v216
    v_mfma_f32_16x16x32_bf16 v[56:59], v[124:127], v[160:163], v[56:59]
    ds_read_b64_tr_b16 v[114:115], v216 offset:1024
    ds_read_b128 v[148:151], v224 offset:2048
    v_mfma_f32_16x16x32_bf16 v[52:55], v[124:127], v[156:159], v[52:55]
    ds_read_b128 v[152:155], v224 offset:4096
    ds_read_b64_tr_b16 v[116:117], v217
    v_mfma_f32_16x16x32_bf16 v[64:67], v[128:131], v[156:159], v[64:67]
    ds_read_b64_tr_b16 v[118:119], v217 offset:1024
    ds_read_b64_tr_b16 v[120:121], v218
    v_mfma_f32_16x16x32_bf16 v[68:71], v[128:131], v[160:163], v[68:71]
    ds_read_b64_tr_b16 v[122:123], v218 offset:1024
    ds_read_b64_tr_b16 v[124:125], v219
    v_mfma_f32_16x16x32_bf16 v[72:75], v[128:131], v[164:167], v[72:75]
    ds_read_b64_tr_b16 v[126:127], v219 offset:1024
    v_mfma_f32_16x16x32_bf16 v[84:87], v[132:135], v[164:167], v[84:87]
    ds_read_b64_tr_b16 v[128:129], v220
    v_mfma_f32_16x16x32_bf16 v[80:83], v[132:135], v[160:163], v[80:83]
    ds_read_b64_tr_b16 v[130:131], v220 offset:1024
    v_mfma_f32_16x16x32_bf16 v[76:79], v[132:135], v[156:159], v[76:79]
    v_mfma_f32_16x16x32_bf16 v[88:91], v[136:139], v[156:159], v[88:91]
    ds_read_b64_tr_b16 v[132:133], v221
    v_mfma_f32_16x16x32_bf16 v[92:95], v[136:139], v[160:163], v[92:95]
    ds_read_b64_tr_b16 v[134:135], v221 offset:1024
    v_mfma_f32_16x16x32_bf16 v[96:99], v[136:139], v[164:167], v[96:99]
    v_mfma_f32_16x16x32_bf16 v[108:111], v[140:143], v[164:167], v[108:111]
    ds_read_b64_tr_b16 v[136:137], v222
    v_mfma_f32_16x16x32_bf16 v[104:107], v[140:143], v[160:163], v[104:107]
    ds_read_b64_tr_b16 v[138:139], v222 offset:1024
    v_mfma_f32_16x16x32_bf16 v[100:103], v[140:143], v[156:159], v[100:103]
    s_waitcnt lgkmcnt(8)
    v_mfma_f32_16x16x32_bf16 v[16:19], v[112:115], v[144:147], v[16:19]
    ds_read_b64_tr_b16 v[140:141], v223
    ds_read_b64_tr_b16 v[142:143], v223 offset:1024
    v_mfma_f32_16x16x32_bf16 v[20:23], v[112:115], v[148:151], v[20:23]
    ds_read_b128 v[156:159], v225
    ds_read_b128 v[160:163], v225 offset:2048
    v_mfma_f32_16x16x32_bf16 v[24:27], v[112:115], v[152:155], v[24:27]
    ds_read_b128 v[164:167], v225 offset:4096
    v_mfma_f32_16x16x32_bf16 v[36:39], v[116:119], v[152:155], v[36:39]
    ds_read_b64_tr_b16 v[112:113], v216 offset:8192
    v_mfma_f32_16x16x32_bf16 v[32:35], v[116:119], v[148:151], v[32:35]
    ds_read_b64_tr_b16 v[114:115], v216 offset:9216
    v_mfma_f32_16x16x32_bf16 v[28:31], v[116:119], v[144:147], v[28:31]
    v_mfma_f32_16x16x32_bf16 v[40:43], v[120:123], v[144:147], v[40:43]
    ds_read_b64_tr_b16 v[116:117], v217 offset:8192
    v_mfma_f32_16x16x32_bf16 v[44:47], v[120:123], v[148:151], v[44:47]
    ds_read_b64_tr_b16 v[118:119], v217 offset:9216
    v_mfma_f32_16x16x32_bf16 v[48:51], v[120:123], v[152:155], v[48:51]
    s_waitcnt lgkmcnt(8)
    v_mfma_f32_16x16x32_bf16 v[60:63], v[124:127], v[152:155], v[60:63]
    ds_read_b64_tr_b16 v[120:121], v218 offset:8192
    v_mfma_f32_16x16x32_bf16 v[56:59], v[124:127], v[148:151], v[56:59]
    ds_read_b64_tr_b16 v[122:123], v218 offset:9216
    v_mfma_f32_16x16x32_bf16 v[52:55], v[124:127], v[144:147], v[52:55]
    v_mfma_f32_16x16x32_bf16 v[64:67], v[128:131], v[144:147], v[64:67]
    ds_read_b64_tr_b16 v[124:125], v219 offset:8192
    v_mfma_f32_16x16x32_bf16 v[68:71], v[128:131], v[148:151], v[68:71]
    ds_read_b64_tr_b16 v[126:127], v219 offset:9216
    v_mfma_f32_16x16x32_bf16 v[72:75], v[128:131], v[152:155], v[72:75]
    v_mfma_f32_16x16x32_bf16 v[84:87], v[132:135], v[152:155], v[84:87]
    ds_read_b64_tr_b16 v[128:129], v220 offset:8192
    v_mfma_f32_16x16x32_bf16 v[80:83], v[132:135], v[148:151], v[80:83]
    ds_read_b64_tr_b16 v[130:131], v220 offset:9216
    v_mfma_f32_16x16x32_bf16 v[76:79], v[132:135], v[144:147], v[76:79]
    v_mfma_f32_16x16x32_bf16 v[88:91], v[136:139], v[144:147], v[88:91]
    ds_read_b64_tr_b16 v[132:133], v221 offset:8192
    v_mfma_f32_16x16x32_bf16 v[92:95], v[136:139], v[148:151], v[92:95]
    ds_read_b64_tr_b16 v[134:135], v221 offset:9216
    v_mfma_f32_16x16x32_bf16 v[96:99], v[136:139], v[152:155], v[96:99]
    s_waitcnt lgkmcnt(8)
    v_mfma_f32_16x16x32_bf16 v[108:111], v[140:143], v[152:155], v[108:111]
    ds_read_b64_tr_b16 v[136:137], v222 offset:8192
    v_mfma_f32_16x16x32_bf16 v[104:107], v[140:143], v[148:151], v[104:107]
    ds_read_b64_tr_b16 v[138:139], v222 offset:9216
    v_mfma_f32_16x16x32_bf16 v[100:103], v[140:143], v[144:147], v[100:103]
    v_mfma_f32_16x16x32_bf16 v[16:19], v[112:115], v[156:159], v[16:19]
    ds_read_b64_tr_b16 v[140:141], v223 offset:8192
    v_mfma_f32_16x16x32_bf16 v[20:23], v[112:115], v[160:163], v[20:23]
    ds_read_b64_tr_b16 v[142:143], v223 offset:9216
    v_mfma_f32_16x16x32_bf16 v[24:27], v[112:115], v[164:167], v[24:27]
    v_mfma_f32_16x16x32_bf16 v[36:39], v[116:119], v[164:167], v[36:39]
    v_mfma_f32_16x16x32_bf16 v[32:35], v[116:119], v[160:163], v[32:35]
    v_mfma_f32_16x16x32_bf16 v[28:31], v[116:119], v[156:159], v[28:31]
    s_waitcnt lgkmcnt(8)
    v_mfma_f32_16x16x32_bf16 v[40:43], v[120:123], v[156:159], v[40:43]
    v_mfma_f32_16x16x32_bf16 v[44:47], v[120:123], v[160:163], v[44:47]
    v_mfma_f32_16x16x32_bf16 v[48:51], v[120:123], v[164:167], v[48:51]
    s_waitcnt lgkmcnt(0)
    s_barrier
    v_mfma_f32_16x16x32_bf16 v[60:63], v[124:127], v[164:167], v[60:63]
    ds_read_b128 v[144:147], v224 offset:40960
    ds_read_b64_tr_b16 v[112:113], v216 offset:40960
    v_mfma_f32_16x16x32_bf16 v[56:59], v[124:127], v[160:163], v[56:59]
    ds_read_b64_tr_b16 v[114:115], v216 offset:41984
    ds_read_b128 v[148:151], v224 offset:43008
    v_mfma_f32_16x16x32_bf16 v[52:55], v[124:127], v[156:159], v[52:55]
    ds_read_b128 v[152:155], v224 offset:45056
    ds_read_b64_tr_b16 v[116:117], v217 offset:40960
    v_mfma_f32_16x16x32_bf16 v[64:67], v[128:131], v[156:159], v[64:67]
    ds_read_b64_tr_b16 v[118:119], v217 offset:41984
    ds_read_b64_tr_b16 v[120:121], v218 offset:40960
    v_mfma_f32_16x16x32_bf16 v[68:71], v[128:131], v[160:163], v[68:71]
    ds_read_b64_tr_b16 v[122:123], v218 offset:41984
    ds_read_b64_tr_b16 v[124:125], v219 offset:40960
    v_mfma_f32_16x16x32_bf16 v[72:75], v[128:131], v[164:167], v[72:75]
    ds_read_b64_tr_b16 v[126:127], v219 offset:41984
    v_mfma_f32_16x16x32_bf16 v[84:87], v[132:135], v[164:167], v[84:87]
    ds_read_b64_tr_b16 v[128:129], v220 offset:40960
    v_mfma_f32_16x16x32_bf16 v[80:83], v[132:135], v[160:163], v[80:83]
    ds_read_b64_tr_b16 v[130:131], v220 offset:41984
    v_mfma_f32_16x16x32_bf16 v[76:79], v[132:135], v[156:159], v[76:79]
    v_mfma_f32_16x16x32_bf16 v[88:91], v[136:139], v[156:159], v[88:91]
    ds_read_b64_tr_b16 v[132:133], v221 offset:40960
    v_mfma_f32_16x16x32_bf16 v[92:95], v[136:139], v[160:163], v[92:95]
    ds_read_b64_tr_b16 v[134:135], v221 offset:41984
    v_mfma_f32_16x16x32_bf16 v[96:99], v[136:139], v[164:167], v[96:99]
    v_mfma_f32_16x16x32_bf16 v[108:111], v[140:143], v[164:167], v[108:111]
    ds_read_b64_tr_b16 v[136:137], v222 offset:40960
    v_mfma_f32_16x16x32_bf16 v[104:107], v[140:143], v[160:163], v[104:107]
    ds_read_b64_tr_b16 v[138:139], v222 offset:41984
    v_mfma_f32_16x16x32_bf16 v[100:103], v[140:143], v[156:159], v[100:103]
    s_waitcnt lgkmcnt(8)
    v_mfma_f32_16x16x32_bf16 v[16:19], v[112:115], v[144:147], v[16:19]
    ds_read_b64_tr_b16 v[140:141], v223 offset:40960
    ds_read_b64_tr_b16 v[142:143], v223 offset:41984
    v_mfma_f32_16x16x32_bf16 v[20:23], v[112:115], v[148:151], v[20:23]
    ds_read_b128 v[156:159], v225 offset:40960
    ds_read_b128 v[160:163], v225 offset:43008
    v_mfma_f32_16x16x32_bf16 v[24:27], v[112:115], v[152:155], v[24:27]
    ds_read_b128 v[164:167], v225 offset:45056
    v_mfma_f32_16x16x32_bf16 v[36:39], v[116:119], v[152:155], v[36:39]
    ds_read_b64_tr_b16 v[112:113], v216 offset:49152
    v_mfma_f32_16x16x32_bf16 v[32:35], v[116:119], v[148:151], v[32:35]
    ds_read_b64_tr_b16 v[114:115], v216 offset:50176
    v_mfma_f32_16x16x32_bf16 v[28:31], v[116:119], v[144:147], v[28:31]
    v_mfma_f32_16x16x32_bf16 v[40:43], v[120:123], v[144:147], v[40:43]
    ds_read_b64_tr_b16 v[116:117], v217 offset:49152
    v_mfma_f32_16x16x32_bf16 v[44:47], v[120:123], v[148:151], v[44:47]
    ds_read_b64_tr_b16 v[118:119], v217 offset:50176
    v_mfma_f32_16x16x32_bf16 v[48:51], v[120:123], v[152:155], v[48:51]
    s_waitcnt lgkmcnt(8)
    v_mfma_f32_16x16x32_bf16 v[60:63], v[124:127], v[152:155], v[60:63]
    ds_read_b64_tr_b16 v[120:121], v218 offset:49152
    v_mfma_f32_16x16x32_bf16 v[56:59], v[124:127], v[148:151], v[56:59]
    ds_read_b64_tr_b16 v[122:123], v218 offset:50176
    v_mfma_f32_16x16x32_bf16 v[52:55], v[124:127], v[144:147], v[52:55]
    v_mfma_f32_16x16x32_bf16 v[64:67], v[128:131], v[144:147], v[64:67]
    ds_read_b64_tr_b16 v[124:125], v219 offset:49152
    v_mfma_f32_16x16x32_bf16 v[68:71], v[128:131], v[148:151], v[68:71]
    ds_read_b64_tr_b16 v[126:127], v219 offset:50176
    v_mfma_f32_16x16x32_bf16 v[72:75], v[128:131], v[152:155], v[72:75]
    v_mfma_f32_16x16x32_bf16 v[84:87], v[132:135], v[152:155], v[84:87]
    ds_read_b64_tr_b16 v[128:129], v220 offset:49152
    v_mfma_f32_16x16x32_bf16 v[80:83], v[132:135], v[148:151], v[80:83]
    ds_read_b64_tr_b16 v[130:131], v220 offset:50176
    v_mfma_f32_16x16x32_bf16 v[76:79], v[132:135], v[144:147], v[76:79]
    v_mfma_f32_16x16x32_bf16 v[88:91], v[136:139], v[144:147], v[88:91]
    ds_read_b64_tr_b16 v[132:133], v221 offset:49152
    v_mfma_f32_16x16x32_bf16 v[92:95], v[136:139], v[148:151], v[92:95]
    ds_read_b64_tr_b16 v[134:135], v221 offset:50176
    v_mfma_f32_16x16x32_bf16 v[96:99], v[136:139], v[152:155], v[96:99]
    s_waitcnt lgkmcnt(8)
    v_mfma_f32_16x16x32_bf16 v[108:111], v[140:143], v[152:155], v[108:111]
    ds_read_b64_tr_b16 v[136:137], v222 offset:49152
    v_mfma_f32_16x16x32_bf16 v[104:107], v[140:143], v[148:151], v[104:107]
    ds_read_b64_tr_b16 v[138:139], v222 offset:50176
    v_mfma_f32_16x16x32_bf16 v[100:103], v[140:143], v[144:147], v[100:103]
    v_mfma_f32_16x16x32_bf16 v[16:19], v[112:115], v[156:159], v[16:19]
    ds_read_b64_tr_b16 v[140:141], v223 offset:49152
    v_mfma_f32_16x16x32_bf16 v[20:23], v[112:115], v[160:163], v[20:23]
    ds_read_b64_tr_b16 v[142:143], v223 offset:50176
    v_mfma_f32_16x16x32_bf16 v[24:27], v[112:115], v[164:167], v[24:27]
    v_mfma_f32_16x16x32_bf16 v[36:39], v[116:119], v[164:167], v[36:39]
    v_mfma_f32_16x16x32_bf16 v[32:35], v[116:119], v[160:163], v[32:35]
    v_mfma_f32_16x16x32_bf16 v[28:31], v[116:119], v[156:159], v[28:31]
    s_waitcnt lgkmcnt(8)
    v_mfma_f32_16x16x32_bf16 v[40:43], v[120:123], v[156:159], v[40:43]
    v_mfma_f32_16x16x32_bf16 v[44:47], v[120:123], v[160:163], v[44:47]
    v_mfma_f32_16x16x32_bf16 v[48:51], v[120:123], v[164:167], v[48:51]
    s_waitcnt lgkmcnt(0)
    s_barrier
    v_mfma_f32_16x16x32_bf16 v[60:63], v[124:127], v[164:167], v[60:63]
    ds_read_b128 v[144:147], v234
    ds_read_b64_tr_b16 v[112:113], v226
    v_mfma_f32_16x16x32_bf16 v[56:59], v[124:127], v[160:163], v[56:59]
    ds_read_b64_tr_b16 v[114:115], v226 offset:1024
    ds_read_b128 v[148:151], v234 offset:2048
    v_mfma_f32_16x16x32_bf16 v[52:55], v[124:127], v[156:159], v[52:55]
    ds_read_b128 v[152:155], v234 offset:4096
    ds_read_b64_tr_b16 v[116:117], v227
    v_mfma_f32_16x16x32_bf16 v[64:67], v[128:131], v[156:159], v[64:67]
    ds_read_b64_tr_b16 v[118:119], v227 offset:1024
    ds_read_b64_tr_b16 v[120:121], v228
    v_mfma_f32_16x16x32_bf16 v[68:71], v[128:131], v[160:163], v[68:71]
    ds_read_b64_tr_b16 v[122:123], v228 offset:1024
    ds_read_b64_tr_b16 v[124:125], v229
    v_mfma_f32_16x16x32_bf16 v[72:75], v[128:131], v[164:167], v[72:75]
    ds_read_b64_tr_b16 v[126:127], v229 offset:1024
    v_mfma_f32_16x16x32_bf16 v[84:87], v[132:135], v[164:167], v[84:87]
    ds_read_b64_tr_b16 v[128:129], v230
    v_mfma_f32_16x16x32_bf16 v[80:83], v[132:135], v[160:163], v[80:83]
    ds_read_b64_tr_b16 v[130:131], v230 offset:1024
    v_mfma_f32_16x16x32_bf16 v[76:79], v[132:135], v[156:159], v[76:79]
    v_mfma_f32_16x16x32_bf16 v[88:91], v[136:139], v[156:159], v[88:91]
    ds_read_b64_tr_b16 v[132:133], v231
    v_mfma_f32_16x16x32_bf16 v[92:95], v[136:139], v[160:163], v[92:95]
    ds_read_b64_tr_b16 v[134:135], v231 offset:1024
    v_mfma_f32_16x16x32_bf16 v[96:99], v[136:139], v[164:167], v[96:99]
    v_mfma_f32_16x16x32_bf16 v[108:111], v[140:143], v[164:167], v[108:111]
    ds_read_b64_tr_b16 v[136:137], v232
    v_mfma_f32_16x16x32_bf16 v[104:107], v[140:143], v[160:163], v[104:107]
    ds_read_b64_tr_b16 v[138:139], v232 offset:1024
    v_mfma_f32_16x16x32_bf16 v[100:103], v[140:143], v[156:159], v[100:103]
    s_waitcnt lgkmcnt(8)
    v_mfma_f32_16x16x32_bf16 v[16:19], v[112:115], v[144:147], v[16:19]
    ds_read_b64_tr_b16 v[140:141], v233
    ds_read_b64_tr_b16 v[142:143], v233 offset:1024
    v_mfma_f32_16x16x32_bf16 v[20:23], v[112:115], v[148:151], v[20:23]
    ds_read_b128 v[156:159], v235
    ds_read_b128 v[160:163], v235 offset:2048
    v_mfma_f32_16x16x32_bf16 v[24:27], v[112:115], v[152:155], v[24:27]
    ds_read_b128 v[164:167], v235 offset:4096
    ds_read_b64 v[168:169], v252
    v_mfma_f32_16x16x32_bf16 v[36:39], v[116:119], v[152:155], v[36:39]
    ds_read_b64 v[170:171], v252 offset:32
    ds_read_b64_tr_b16 v[112:113], v226 offset:8192
    v_mfma_f32_16x16x32_bf16 v[32:35], v[116:119], v[148:151], v[32:35]
    ds_read_b64_tr_b16 v[114:115], v226 offset:9216
    ds_read_b64 v[172:173], v253
    v_mfma_f32_16x16x32_bf16 v[28:31], v[116:119], v[144:147], v[28:31]
    ds_read_b64 v[174:175], v253 offset:32
    v_mfma_f32_16x16x32_bf16 v[40:43], v[120:123], v[144:147], v[40:43]
    ds_read_b64_tr_b16 v[116:117], v227 offset:8192
    ds_read_b64_tr_b16 v[118:119], v227 offset:9216
    v_mfma_f32_16x16x32_bf16 v[44:47], v[120:123], v[148:151], v[44:47]
    ds_read_b64 v[176:177], v254
    v_mfma_f32_16x16x32_bf16 v[48:51], v[120:123], v[152:155], v[48:51]
    ds_read_b64 v[178:179], v254 offset:32
    s_waitcnt lgkmcnt(8)
    v_mfma_f32_16x16x32_bf16 v[60:63], v[124:127], v[152:155], v[60:63]
    ds_read_b64_tr_b16 v[120:121], v228 offset:8192
    ds_read_b64_tr_b16 v[122:123], v228 offset:9216
    v_mfma_f32_16x16x32_bf16 v[56:59], v[124:127], v[148:151], v[56:59]
    ds_read_b64 v[180:181], v255
    v_mfma_f32_16x16x32_bf16 v[52:55], v[124:127], v[144:147], v[52:55]
    ds_read_b64 v[182:183], v255 offset:32
    v_mfma_f32_16x16x32_bf16 v[64:67], v[128:131], v[144:147], v[64:67]
    ds_read_b64_tr_b16 v[124:125], v229 offset:8192
    ds_read_b64_tr_b16 v[126:127], v229 offset:9216
    v_mfma_f32_16x16x32_bf16 v[68:71], v[128:131], v[148:151], v[68:71]
    ds_read_b64 v[184:185], v252 offset:16448
    v_mfma_f32_16x16x32_bf16 v[72:75], v[128:131], v[152:155], v[72:75]
    ds_read_b64 v[186:187], v252 offset:16480
    v_mfma_f32_16x16x32_bf16 v[84:87], v[132:135], v[152:155], v[84:87]
    ds_read_b64_tr_b16 v[128:129], v230 offset:8192
    ds_read_b64_tr_b16 v[130:131], v230 offset:9216
    v_mfma_f32_16x16x32_bf16 v[80:83], v[132:135], v[148:151], v[80:83]
    ds_read_b64 v[188:189], v253 offset:16448
    v_mfma_f32_16x16x32_bf16 v[76:79], v[132:135], v[144:147], v[76:79]
    ds_read_b64 v[190:191], v253 offset:16480
    v_mfma_f32_16x16x32_bf16 v[88:91], v[136:139], v[144:147], v[88:91]
    ds_read_b64_tr_b16 v[132:133], v231 offset:8192
    ds_read_b64_tr_b16 v[134:135], v231 offset:9216
    v_mfma_f32_16x16x32_bf16 v[92:95], v[136:139], v[148:151], v[92:95]
    ds_read_b64 v[192:193], v254 offset:16448
    v_mfma_f32_16x16x32_bf16 v[96:99], v[136:139], v[152:155], v[96:99]
    ds_read_b64 v[194:195], v254 offset:16480
    v_mfma_f32_16x16x32_bf16 v[108:111], v[140:143], v[152:155], v[108:111]
    ds_read_b64_tr_b16 v[136:137], v232 offset:8192
    ds_read_b64_tr_b16 v[138:139], v232 offset:9216
    v_mfma_f32_16x16x32_bf16 v[104:107], v[140:143], v[148:151], v[104:107]
    ds_read_b64 v[196:197], v255 offset:16448
    v_mfma_f32_16x16x32_bf16 v[100:103], v[140:143], v[144:147], v[100:103]
    ds_read_b64 v[198:199], v255 offset:16480
    s_waitcnt lgkmcnt(8)
    v_mfma_f32_16x16x32_bf16 v[16:19], v[112:115], v[156:159], v[16:19]
    ds_read_b64_tr_b16 v[140:141], v233 offset:8192
    v_mfma_f32_16x16x32_bf16 v[20:23], v[112:115], v[160:163], v[20:23]
    ds_read_b64_tr_b16 v[142:143], v233 offset:9216
    v_mfma_f32_16x16x32_bf16 v[24:27], v[112:115], v[164:167], v[24:27]
    v_mfma_f32_16x16x32_bf16 v[36:39], v[116:119], v[164:167], v[36:39]
    v_mfma_f32_16x16x32_bf16 v[32:35], v[116:119], v[160:163], v[32:35]
    v_mfma_f32_16x16x32_bf16 v[28:31], v[116:119], v[156:159], v[28:31]
    v_mfma_f32_16x16x32_bf16 v[40:43], v[120:123], v[156:159], v[40:43]
    v_mfma_f32_16x16x32_bf16 v[44:47], v[120:123], v[160:163], v[44:47]
    v_mfma_f32_16x16x32_bf16 v[48:51], v[120:123], v[164:167], v[48:51]
    v_mfma_f32_16x16x32_bf16 v[60:63], v[124:127], v[164:167], v[60:63]
    v_mfma_f32_16x16x32_bf16 v[56:59], v[124:127], v[160:163], v[56:59]
    v_mfma_f32_16x16x32_bf16 v[52:55], v[124:127], v[156:159], v[52:55]
    v_mfma_f32_16x16x32_bf16 v[64:67], v[128:131], v[156:159], v[64:67]
    v_cvt_pk_bf16_f32 v16, v16, v17
    v_cvt_pk_bf16_f32 v17, v18, v19
    v_mfma_f32_16x16x32_bf16 v[68:71], v[128:131], v[160:163], v[68:71]
    v_cvt_pk_bf16_f32 v18, v28, v29
    v_cvt_pk_bf16_f32 v19, v30, v31
    v_mfma_f32_16x16x32_bf16 v[72:75], v[128:131], v[164:167], v[72:75]
    v_cvt_pk_bf16_f32 v20, v20, v21
    v_cvt_pk_bf16_f32 v21, v22, v23
    s_waitcnt lgkmcnt(8)
    v_mfma_f32_16x16x32_bf16 v[84:87], v[132:135], v[164:167], v[84:87]
    v_cvt_pk_bf16_f32 v22, v32, v33
    v_cvt_pk_bf16_f32 v23, v34, v35
    v_mfma_f32_16x16x32_bf16 v[80:83], v[132:135], v[160:163], v[80:83]
    v_cvt_pk_bf16_f32 v24, v24, v25
    v_cvt_pk_bf16_f32 v25, v26, v27
    v_mfma_f32_16x16x32_bf16 v[76:79], v[132:135], v[156:159], v[76:79]
    v_cvt_pk_bf16_f32 v26, v36, v37
    s_waitcnt lgkmcnt(4)
    v_mfma_f32_16x16x32_bf16 v[88:91], v[136:139], v[156:159], v[88:91]
    v_cvt_pk_bf16_f32 v27, v38, v39
    v_cvt_pk_bf16_f32 v40, v40, v41
    v_mfma_f32_16x16x32_bf16 v[92:95], v[136:139], v[160:163], v[92:95]
    v_cvt_pk_bf16_f32 v41, v42, v43
    v_cvt_pk_bf16_f32 v42, v52, v53
    v_mfma_f32_16x16x32_bf16 v[96:99], v[136:139], v[164:167], v[96:99]
    v_cvt_pk_bf16_f32 v43, v54, v55
    v_cvt_pk_bf16_f32 v44, v44, v45
    s_waitcnt lgkmcnt(0)
    v_mfma_f32_16x16x32_bf16 v[108:111], v[140:143], v[164:167], v[108:111]
    v_cvt_pk_bf16_f32 v45, v46, v47
    v_cvt_pk_bf16_f32 v46, v56, v57
    v_mfma_f32_16x16x32_bf16 v[104:107], v[140:143], v[160:163], v[104:107]
    v_cvt_pk_bf16_f32 v47, v58, v59
    v_cvt_pk_bf16_f32 v48, v48, v49
    v_mfma_f32_16x16x32_bf16 v[100:103], v[140:143], v[156:159], v[100:103]
    v_cvt_pk_bf16_f32 v49, v50, v51
    v_cvt_pk_bf16_f32 v50, v60, v61
    s_waitcnt lgkmcnt(0)
    s_barrier
    ds_read_b64 v[200:201], v252 offset:32896
    ds_read_b64 v[202:203], v252 offset:32928
    ds_read_b64 v[204:205], v253 offset:32896
    ds_read_b64 v[206:207], v253 offset:32928
    ds_read_b64 v[208:209], v254 offset:32896
    ds_read_b64 v[210:211], v254 offset:32928
    ds_read_b64 v[212:213], v255 offset:32896
    ds_read_b64 v[214:215], v255 offset:32928
    buffer_load_dwordx4 v[252:255], v10, s[64:67], 0 offen sc1
    v_mfma_f32_16x16x32_bf16 v[216:219], v[168:171], v[16:19], 0
    v_cvt_pk_bf16_f32 v51, v62, v63
    v_cvt_pk_bf16_f32 v64, v64, v65
    v_mfma_f32_16x16x32_bf16 v[220:223], v[168:171], v[20:23], 0
    v_cvt_pk_bf16_f32 v65, v66, v67
    v_cvt_pk_bf16_f32 v66, v76, v77
    v_mfma_f32_16x16x32_bf16 v[224:227], v[168:171], v[24:27], 0
    v_cvt_pk_bf16_f32 v67, v78, v79
    v_cvt_pk_bf16_f32 v68, v68, v69
    v_mfma_f32_16x16x32_bf16 v[228:231], v[184:187], v[16:19], 0
    v_cvt_pk_bf16_f32 v69, v70, v71
    v_cvt_pk_bf16_f32 v70, v80, v81
    v_mfma_f32_16x16x32_bf16 v[232:235], v[184:187], v[20:23], 0
    v_cvt_pk_bf16_f32 v71, v82, v83
    v_cvt_pk_bf16_f32 v72, v72, v73
    v_mfma_f32_16x16x32_bf16 v[236:239], v[184:187], v[24:27], 0
    v_cvt_pk_bf16_f32 v73, v74, v75
    v_cvt_pk_bf16_f32 v74, v84, v85
    v_mfma_f32_16x16x32_bf16 v[216:219], v[172:175], v[40:43], v[216:219]
    v_cvt_pk_bf16_f32 v75, v86, v87
    v_cvt_pk_bf16_f32 v88, v88, v89
    v_mfma_f32_16x16x32_bf16 v[220:223], v[172:175], v[44:47], v[220:223]
    v_cvt_pk_bf16_f32 v89, v90, v91
    v_cvt_pk_bf16_f32 v90, v100, v101
    v_mfma_f32_16x16x32_bf16 v[224:227], v[172:175], v[48:51], v[224:227]
    v_cvt_pk_bf16_f32 v91, v102, v103
    v_cvt_pk_bf16_f32 v92, v92, v93
    v_mfma_f32_16x16x32_bf16 v[228:231], v[188:191], v[40:43], v[228:231]
    v_cvt_pk_bf16_f32 v93, v94, v95
    v_cvt_pk_bf16_f32 v94, v104, v105
    v_mfma_f32_16x16x32_bf16 v[232:235], v[188:191], v[44:47], v[232:235]
    v_cvt_pk_bf16_f32 v95, v106, v107
    v_cvt_pk_bf16_f32 v96, v96, v97
    v_mfma_f32_16x16x32_bf16 v[236:239], v[188:191], v[48:51], v[236:239]
    v_cvt_pk_bf16_f32 v97, v98, v99
    v_cvt_pk_bf16_f32 v98, v108, v109
    v_mfma_f32_16x16x32_bf16 v[216:219], v[176:179], v[64:67], v[216:219]
    v_cvt_pk_bf16_f32 v99, v110, v111
    v_mfma_f32_16x16x32_bf16 v[220:223], v[176:179], v[68:71], v[220:223]
    v_mfma_f32_16x16x32_bf16 v[224:227], v[176:179], v[72:75], v[224:227]
    v_mfma_f32_16x16x32_bf16 v[228:231], v[192:195], v[64:67], v[228:231]
    v_mfma_f32_16x16x32_bf16 v[232:235], v[192:195], v[68:71], v[232:235]
    v_mfma_f32_16x16x32_bf16 v[236:239], v[192:195], v[72:75], v[236:239]
    s_waitcnt lgkmcnt(6)
    v_mfma_f32_16x16x32_bf16 v[240:243], v[200:203], v[16:19], 0
    v_mfma_f32_16x16x32_bf16 v[244:247], v[200:203], v[20:23], 0
    v_mfma_f32_16x16x32_bf16 v[248:251], v[200:203], v[24:27], 0
    s_waitcnt lgkmcnt(4)
    v_mfma_f32_16x16x32_bf16 v[240:243], v[204:207], v[40:43], v[240:243]
    v_mfma_f32_16x16x32_bf16 v[244:247], v[204:207], v[44:47], v[244:247]
    v_mfma_f32_16x16x32_bf16 v[248:251], v[204:207], v[48:51], v[248:251]
    s_waitcnt lgkmcnt(2)
    v_mfma_f32_16x16x32_bf16 v[240:243], v[208:211], v[64:67], v[240:243]
    v_mfma_f32_16x16x32_bf16 v[244:247], v[208:211], v[68:71], v[244:247]
    v_mfma_f32_16x16x32_bf16 v[248:251], v[208:211], v[72:75], v[248:251]
    v_mfma_f32_16x16x32_bf16 v[216:219], v[180:183], v[88:91], v[216:219]
    v_mfma_f32_16x16x32_bf16 v[228:231], v[196:199], v[88:91], v[228:231]
    s_waitcnt lgkmcnt(0)
    v_mfma_f32_16x16x32_bf16 v[240:243], v[212:215], v[88:91], v[240:243]
    v_mfma_f32_16x16x32_bf16 v[220:223], v[180:183], v[92:95], v[220:223]
    v_mfma_f32_16x16x32_bf16 v[232:235], v[196:199], v[92:95], v[232:235]
    v_mfma_f32_16x16x32_bf16 v[244:247], v[212:215], v[92:95], v[244:247]
    v_mfma_f32_16x16x32_bf16 v[224:227], v[180:183], v[96:99], v[224:227]
    v_mfma_f32_16x16x32_bf16 v[236:239], v[196:199], v[96:99], v[236:239]
    v_mfma_f32_16x16x32_bf16 v[248:251], v[212:215], v[96:99], v[248:251]
    v_max3_f32 v160, v216, v217, v218
    s_nop 1
    v_max3_f32 v162, v220, v221, v222
    s_nop 1
    v_max3_f32 v164, v224, v225, v226
    v_max3_f32 v160, v160, v219, v228
    v_max3_f32 v162, v162, v223, v232
    v_max3_f32 v164, v164, v227, v236
    v_max3_f32 v160, v160, v229, v230
    v_max3_f32 v162, v162, v233, v234
    v_max3_f32 v164, v164, v237, v238
    v_max3_f32 v160, v160, v231, v240
    v_max3_f32 v162, v162, v235, v244
    v_max3_f32 v164, v164, v239, v248
    v_max3_f32 v160, v160, v241, v242
    v_max3_f32 v162, v162, v245, v246
    v_max3_f32 v164, v164, v249, v250
    v_max_f32 v160, v160, v243
    v_max_f32 v162, v162, v247
    v_max_f32 v164, v164, v251
    v_mov_b32 v161, v160
    v_mov_b32 v163, v162
    v_mov_b32 v165, v164
    v_permlane32_swap_b32 v160, v161
    v_permlane32_swap_b32 v162, v163
    v_permlane32_swap_b32 v164, v165
    v_max_f32 v160, v160, v161
    v_max_f32 v162, v162, v163
    v_max_f32 v164, v164, v165
    v_mov_b32 v161, v160
    v_mov_b32 v163, v162
    v_mov_b32 v165, v164
    v_permlane16_swap_b32 v160, v161
    v_permlane16_swap_b32 v162, v163
    v_permlane16_swap_b32 v164, v165
    v_max_f32 v160, v160, v161
    v_max_f32 v162, v162, v163
    v_max_f32 v164, v164, v165
    v_mul_f32 v160, s83, v160
    v_mul_f32 v162, s83, v162
    v_mul_f32 v164, s83, v164
    v_pk_fma_f32 v[216:217], v[216:217], s[82:83], v[160:161] op_sel:[0,1,0] op_sel_hi:[1,1,0] neg_lo:[0,0,1] neg_hi:[0,0,1]
    v_pk_fma_f32 v[220:221], v[220:221], s[82:83], v[162:163] op_sel:[0,1,0] op_sel_hi:[1,1,0] neg_lo:[0,0,1] neg_hi:[0,0,1]
    v_pk_fma_f32 v[224:225], v[224:225], s[82:83], v[164:165] op_sel:[0,1,0] op_sel_hi:[1,1,0] neg_lo:[0,0,1] neg_hi:[0,0,1]
    v_pk_fma_f32 v[218:219], v[218:219], s[82:83], v[160:161] op_sel:[0,1,0] op_sel_hi:[1,1,0] neg_lo:[0,0,1] neg_hi:[0,0,1]
    v_pk_fma_f32 v[222:223], v[222:223], s[82:83], v[162:163] op_sel:[0,1,0] op_sel_hi:[1,1,0] neg_lo:[0,0,1] neg_hi:[0,0,1]
    v_pk_fma_f32 v[226:227], v[226:227], s[82:83], v[164:165] op_sel:[0,1,0] op_sel_hi:[1,1,0] neg_lo:[0,0,1] neg_hi:[0,0,1]
    v_pk_fma_f32 v[228:229], v[228:229], s[82:83], v[160:161] op_sel:[0,1,0] op_sel_hi:[1,1,0] neg_lo:[0,0,1] neg_hi:[0,0,1]
    v_pk_fma_f32 v[232:233], v[232:233], s[82:83], v[162:163] op_sel:[0,1,0] op_sel_hi:[1,1,0] neg_lo:[0,0,1] neg_hi:[0,0,1]
    v_pk_fma_f32 v[236:237], v[236:237], s[82:83], v[164:165] op_sel:[0,1,0] op_sel_hi:[1,1,0] neg_lo:[0,0,1] neg_hi:[0,0,1]
    v_pk_fma_f32 v[230:231], v[230:231], s[82:83], v[160:161] op_sel:[0,1,0] op_sel_hi:[1,1,0] neg_lo:[0,0,1] neg_hi:[0,0,1]
    v_pk_fma_f32 v[234:235], v[234:235], s[82:83], v[162:163] op_sel:[0,1,0] op_sel_hi:[1,1,0] neg_lo:[0,0,1] neg_hi:[0,0,1]
    v_pk_fma_f32 v[238:239], v[238:239], s[82:83], v[164:165] op_sel:[0,1,0] op_sel_hi:[1,1,0] neg_lo:[0,0,1] neg_hi:[0,0,1]
    v_pk_fma_f32 v[240:241], v[240:241], s[82:83], v[160:161] op_sel:[0,1,0] op_sel_hi:[1,1,0] neg_lo:[0,0,1] neg_hi:[0,0,1]
    v_pk_fma_f32 v[244:245], v[244:245], s[82:83], v[162:163] op_sel:[0,1,0] op_sel_hi:[1,1,0] neg_lo:[0,0,1] neg_hi:[0,0,1]
    v_pk_fma_f32 v[248:249], v[248:249], s[82:83], v[164:165] op_sel:[0,1,0] op_sel_hi:[1,1,0] neg_lo:[0,0,1] neg_hi:[0,0,1]
    v_pk_fma_f32 v[242:243], v[242:243], s[82:83], v[160:161] op_sel:[0,1,0] op_sel_hi:[1,1,0] neg_lo:[0,0,1] neg_hi:[0,0,1]
    v_pk_fma_f32 v[246:247], v[246:247], s[82:83], v[162:163] op_sel:[0,1,0] op_sel_hi:[1,1,0] neg_lo:[0,0,1] neg_hi:[0,0,1]
    v_pk_fma_f32 v[250:251], v[250:251], s[82:83], v[164:165] op_sel:[0,1,0] op_sel_hi:[1,1,0] neg_lo:[0,0,1] neg_hi:[0,0,1]
    v_exp_f32 v216, v216
    v_exp_f32 v220, v220
    v_exp_f32 v224, v224
    v_exp_f32 v217, v217
    v_exp_f32 v221, v221
    v_exp_f32 v225, v225
    v_exp_f32 v218, v218
    v_exp_f32 v222, v222
    v_exp_f32 v226, v226
    v_exp_f32 v219, v219
    v_exp_f32 v223, v223
    v_exp_f32 v227, v227
    v_exp_f32 v228, v228
    v_exp_f32 v232, v232
    v_exp_f32 v236, v236
    v_exp_f32 v229, v229
    v_exp_f32 v233, v233
    v_exp_f32 v237, v237
    v_exp_f32 v230, v230
    v_exp_f32 v234, v234
    v_exp_f32 v238, v238
    v_exp_f32 v231, v231
    v_exp_f32 v235, v235
    v_exp_f32 v239, v239
    v_exp_f32 v240, v240
    v_exp_f32 v244, v244
    v_exp_f32 v248, v248
    v_exp_f32 v241, v241
    v_exp_f32 v245, v245
    v_exp_f32 v249, v249
    v_exp_f32 v242, v242
    v_exp_f32 v246, v246
    v_exp_f32 v250, v250
    v_exp_f32 v243, v243
    v_exp_f32 v247, v247
    v_exp_f32 v251, v251
    v_pk_add_f32 v[166:167], v[216:217], v[218:219]
    s_waitcnt vmcnt(1)
    v_pk_add_f32 v[6:7], v[220:221], v[222:223]
    v_pk_add_f32 v[112:113], v[224:225], v[226:227]
    v_pk_add_f32 v[166:167], v[166:167], v[228:229]
    v_pk_add_f32 v[6:7], v[6:7], v[232:233]
    v_pk_add_f32 v[112:113], v[112:113], v[236:237]
    v_pk_add_f32 v[166:167], v[166:167], v[230:231]
    v_pk_add_f32 v[6:7], v[6:7], v[234:235]
    v_pk_add_f32 v[112:113], v[112:113], v[238:239]
    v_pk_add_f32 v[166:167], v[166:167], v[240:241]
    v_pk_add_f32 v[6:7], v[6:7], v[244:245]
    v_pk_add_f32 v[112:113], v[112:113], v[248:249]
    v_pk_add_f32 v[166:167], v[166:167], v[242:243]
    v_pk_add_f32 v[6:7], v[6:7], v[246:247]
    v_pk_add_f32 v[112:113], v[112:113], v[250:251]
    v_add_f32 v160, v166, v167
    v_add_f32 v162, v6, v7
    v_add_f32 v164, v112, v113
    v_mov_b32 v161, v160
    v_mov_b32 v163, v162
    v_mov_b32 v165, v164
    v_permlane32_swap_b32 v160, v161
    v_permlane32_swap_b32 v162, v163
    v_permlane32_swap_b32 v164, v165
    v_add_f32 v160, v160, v161
    v_add_f32 v162, v162, v163
    v_add_f32 v164, v164, v165
    v_mov_b32 v161, v160
    v_mov_b32 v163, v162
    v_mov_b32 v165, v164
    v_permlane16_swap_b32 v160, v161
    v_permlane16_swap_b32 v162, v163
    v_permlane16_swap_b32 v164, v165
    v_add_f32 v160, v160, v161
    v_add_f32 v162, v162, v163
    v_add_f32 v164, v164, v165
    v_rcp_f32 v160, v160
    v_rcp_f32 v162, v162
    v_rcp_f32 v164, v164
    v_pk_mul_f32 v[216:217], v[216:217], v[160:161] op_sel_hi:[1,0]
    v_pk_mul_f32 v[220:221], v[220:221], v[162:163] op_sel_hi:[1,0]
    v_pk_mul_f32 v[224:225], v[224:225], v[164:165] op_sel_hi:[1,0]
    v_pk_mul_f32 v[218:219], v[218:219], v[160:161] op_sel_hi:[1,0]
    v_pk_mul_f32 v[222:223], v[222:223], v[162:163] op_sel_hi:[1,0]
    v_pk_mul_f32 v[226:227], v[226:227], v[164:165] op_sel_hi:[1,0]
    v_pk_mul_f32 v[228:229], v[228:229], v[160:161] op_sel_hi:[1,0]
    v_pk_mul_f32 v[232:233], v[232:233], v[162:163] op_sel_hi:[1,0]
    v_pk_mul_f32 v[236:237], v[236:237], v[164:165] op_sel_hi:[1,0]
    v_pk_mul_f32 v[230:231], v[230:231], v[160:161] op_sel_hi:[1,0]
    v_pk_mul_f32 v[234:235], v[234:235], v[162:163] op_sel_hi:[1,0]
    v_pk_mul_f32 v[238:239], v[238:239], v[164:165] op_sel_hi:[1,0]
    v_pk_mul_f32 v[240:241], v[240:241], v[160:161] op_sel_hi:[1,0]
    v_pk_mul_f32 v[244:245], v[244:245], v[162:163] op_sel_hi:[1,0]
    v_pk_mul_f32 v[248:249], v[248:249], v[164:165] op_sel_hi:[1,0]
    v_pk_mul_f32 v[242:243], v[242:243], v[160:161] op_sel_hi:[1,0]
    v_pk_mul_f32 v[246:247], v[246:247], v[162:163] op_sel_hi:[1,0]
    v_pk_mul_f32 v[250:251], v[250:251], v[164:165] op_sel_hi:[1,0]
    v_cvt_pk_bf16_f32 v216, v216, v217
    v_cvt_pk_bf16_f32 v217, v218, v219
    v_cvt_pk_bf16_f32 v218, v228, v229
    v_cvt_pk_bf16_f32 v219, v230, v231
    v_cvt_pk_bf16_f32 v240, v240, v241
    v_cvt_pk_bf16_f32 v241, v242, v243
    v_cvt_pk_bf16_f32 v220, v220, v221
    v_cvt_pk_bf16_f32 v221, v222, v223
    v_cvt_pk_bf16_f32 v222, v232, v233
    v_cvt_pk_bf16_f32 v223, v234, v235
    v_cvt_pk_bf16_f32 v244, v244, v245
    v_cvt_pk_bf16_f32 v245, v246, v247
    v_cvt_pk_bf16_f32 v224, v224, v225
    v_cvt_pk_bf16_f32 v225, v226, v227
    v_cvt_pk_bf16_f32 v226, v236, v237
    v_cvt_pk_bf16_f32 v227, v238, v239
    v_cvt_pk_bf16_f32 v248, v248, v249
    v_cvt_pk_bf16_f32 v249, v250, v251
    s_barrier
    ds_read_b64_tr_b16 v[112:113], v2
    ds_read_b64_tr_b16 v[114:115], v2 offset:16512
    ds_read_b64_tr_b16 v[116:117], v2 offset:33024
    ds_read_b64_tr_b16 v[118:119], v2 offset:32
    ds_read_b64_tr_b16 v[120:121], v2 offset:16544
    ds_read_b64_tr_b16 v[122:123], v2 offset:33056
    ds_read_b64_tr_b16 v[124:125], v3
    ds_read_b64_tr_b16 v[126:127], v3 offset:16512
    ds_read_b64_tr_b16 v[128:129], v3 offset:33024
    ds_read_b64_tr_b16 v[130:131], v3 offset:32
    ds_read_b64_tr_b16 v[132:133], v3 offset:16544
    ds_read_b64_tr_b16 v[134:135], v3 offset:33056
    ds_read_b64_tr_b16 v[136:137], v4
    ds_read_b64_tr_b16 v[138:139], v4 offset:16512
    ds_read_b64_tr_b16 v[140:141], v4 offset:33024
    ds_read_b64_tr_b16 v[142:143], v4 offset:32
    ds_read_b64_tr_b16 v[144:145], v4 offset:16544
    ds_read_b64_tr_b16 v[146:147], v4 offset:33056
    ds_read_b64_tr_b16 v[148:149], v5
    ds_read_b64_tr_b16 v[150:151], v5 offset:16512
    ds_read_b64_tr_b16 v[152:153], v5 offset:33024
    ds_read_b64_tr_b16 v[154:155], v5 offset:32
    ds_read_b64_tr_b16 v[156:157], v5 offset:16544
    ds_read_b64_tr_b16 v[158:159], v5 offset:33056
    s_mov_b32 s77, 0
    s_waitcnt vmcnt(0)
    v_readfirstlane_b32 s76, v252
    v_readfirstlane_b32 s75, v254
    v_readfirstlane_b32 s3, v255
Lnsp_6:
    s_cmp_lg_u32 s76, 0
    s_cselect_b32 s76, s75, 0
    s_cmp_ge_u32 s3, 524288
    s_cselect_b32 s76, s76, 0
    s_cmp_ge_u32 s76, 536870912
    s_cbranch_scc1 Lnok_5
    s_add_u32 s77, s77, 1
    s_cmp_gt_u32 s77, 131072
    s_cbranch_scc1 Lnok_5
    buffer_load_dwordx4 v[252:255], v10, s[64:67], 0 offen sc1
    s_waitcnt vmcnt(0)
    v_readfirstlane_b32 s76, v252
    v_readfirstlane_b32 s75, v254
    v_readfirstlane_b32 s3, v255
    s_nop 0
    s_branch Lnsp_6
Lnok_5:
    v_mov_b32 v8, v252
    v_mov_b32 v9, v253
    s_cmp_gt_u32 s76, 537001952
    s_cselect_b32 s76, 0xff, 0
    s_xor_b32 s75, s3, s76
    s_and_b32 s76, s2, 4
    s_lshr_b32 s75, s75, s76
    s_lshr_b32 s76, s75, s69
    s_and_b32 s76, s76, 1
    s_lshl_b32 s76, s76, 13
    s_xor_b32 s80, s80, s76
    s_xor_b32 s84, s84, s76
    s_xor_b32 s88, s88, s76
    s_mov_b32 s52, s76
    s_mov_b32 s53, s75
    s_lshl_b32 s81, s98, 15
    s_add_u32 s81, s81, s80
    s_waitcnt lgkmcnt(8)
    v_mfma_f32_16x16x32_bf16 v[16:19], v[112:115], v[216:219], 0
    s_bitcmp1_b32 s53, 0
    s_cselect_b32 s44, 8192, 0
    s_xor_b32 s44, s44, s92
    v_mfma_f32_16x16x32_bf16 v[48:51], v[112:115], v[220:223], 0
    s_bitcmp1_b32 s53, 1
    s_cselect_b32 s45, 8192, 0
    s_xor_b32 s45, s45, s92
    v_mfma_f32_16x16x32_bf16 v[80:83], v[112:115], v[224:227], 0
    s_bitcmp1_b32 s53, 2
    s_cselect_b32 s46, 8192, 0
    s_xor_b32 s46, s46, s92
    v_mfma_f32_16x16x32_bf16 v[20:23], v[118:121], v[216:219], 0
    s_bitcmp1_b32 s53, 3
    s_cselect_b32 s47, 8192, 0
    s_xor_b32 s47, s47, s92
    v_mfma_f32_16x16x32_bf16 v[52:55], v[118:121], v[220:223], 0
    v_mfma_f32_16x16x32_bf16 v[84:87], v[118:121], v[224:227], 0
    v_mfma_f32_16x16x16_bf16 v[16:19], v[116:117], v[240:241], v[16:19]
    v_mfma_f32_16x16x16_bf16 v[48:51], v[116:117], v[244:245], v[48:51]
    v_mfma_f32_16x16x16_bf16 v[80:83], v[116:117], v[248:249], v[80:83]
    v_mfma_f32_16x16x16_bf16 v[20:23], v[122:123], v[240:241], v[20:23]
    s_nop 0
    v_mfma_f32_16x16x16_bf16 v[52:55], v[122:123], v[244:245], v[52:55]
    v_mfma_f32_16x16x16_bf16 v[84:87], v[122:123], v[248:249], v[84:87]
    v_mfma_f32_16x16x32_bf16 v[24:27], v[124:127], v[216:219], 0
    v_mfma_f32_16x16x32_bf16 v[56:59], v[124:127], v[220:223], 0
    v_mfma_f32_16x16x32_bf16 v[88:91], v[124:127], v[224:227], 0
    v_cvt_pk_bf16_f32 v168, v16, v17
    v_cvt_pk_bf16_f32 v169, v18, v19
    v_mfma_f32_16x16x32_bf16 v[28:31], v[130:133], v[216:219], 0
    v_cvt_pk_bf16_f32 v170, v20, v21
    v_cvt_pk_bf16_f32 v171, v22, v23
    v_mfma_f32_16x16x32_bf16 v[60:63], v[130:133], v[220:223], 0
    s_add_u32 s82, s81, s40
    buffer_store_dwordx4 v[168:171], v14, s[60:63], s82 offen sc1
    v_mfma_f32_16x16x32_bf16 v[92:95], v[130:133], v[224:227], 0
    v_cvt_pk_bf16_f32 v172, v48, v49
    v_cvt_pk_bf16_f32 v173, v50, v51
    v_mfma_f32_16x16x16_bf16 v[24:27], v[128:129], v[240:241], v[24:27]
    v_cvt_pk_bf16_f32 v174, v52, v53
    v_cvt_pk_bf16_f32 v175, v54, v55
    v_mfma_f32_16x16x16_bf16 v[56:59], v[128:129], v[244:245], v[56:59]
    s_add_u32 s82, s81, s40
    buffer_store_dwordx4 v[172:175], v14, s[60:63], s82 offen offset:1024 sc1
    v_mfma_f32_16x16x16_bf16 v[88:91], v[128:129], v[248:249], v[88:91]
    v_cvt_pk_bf16_f32 v176, v80, v81
    v_cvt_pk_bf16_f32 v177, v82, v83
    v_mfma_f32_16x16x16_bf16 v[28:31], v[134:135], v[240:241], v[28:31]
    v_cvt_pk_bf16_f32 v178, v84, v85
    v_cvt_pk_bf16_f32 v179, v86, v87
    v_mfma_f32_16x16x16_bf16 v[60:63], v[134:135], v[244:245], v[60:63]
    s_add_u32 s82, s81, s40
    buffer_store_dwordx4 v[176:179], v14, s[60:63], s82 offen offset:2048 sc1
    v_mfma_f32_16x16x16_bf16 v[92:95], v[134:135], v[248:249], v[92:95]
    v_mfma_f32_16x16x32_bf16 v[32:35], v[136:139], v[216:219], 0
    v_mfma_f32_16x16x32_bf16 v[64:67], v[136:139], v[220:223], 0
    v_mfma_f32_16x16x32_bf16 v[96:99], v[136:139], v[224:227], 0
    v_cvt_pk_bf16_f32 v180, v24, v25
    v_cvt_pk_bf16_f32 v181, v26, v27
    s_waitcnt lgkmcnt(7)
    v_mfma_f32_16x16x32_bf16 v[36:39], v[142:145], v[216:219], 0
    v_cvt_pk_bf16_f32 v182, v28, v29
    v_cvt_pk_bf16_f32 v183, v30, v31
    v_mfma_f32_16x16x32_bf16 v[68:71], v[142:145], v[220:223], 0
    s_add_u32 s82, s81, s40
    buffer_store_dwordx4 v[180:183], v14, s[60:63], s82 offen offset:3072 sc1
    v_mfma_f32_16x16x32_bf16 v[100:103], v[142:145], v[224:227], 0
    v_cvt_pk_bf16_f32 v184, v56, v57
    v_cvt_pk_bf16_f32 v185, v58, v59
    v_mfma_f32_16x16x16_bf16 v[32:35], v[140:141], v[240:241], v[32:35]
    v_cvt_pk_bf16_f32 v186, v60, v61
    v_cvt_pk_bf16_f32 v187, v62, v63
    v_mfma_f32_16x16x16_bf16 v[64:67], v[140:141], v[244:245], v[64:67]
    s_add_u32 s82, s81, s41
    buffer_store_dwordx4 v[184:187], v14, s[60:63], s82 offen sc1
    v_mfma_f32_16x16x16_bf16 v[96:99], v[140:141], v[248:249], v[96:99]
    v_cvt_pk_bf16_f32 v188, v88, v89
    v_cvt_pk_bf16_f32 v189, v90, v91
    s_waitcnt lgkmcnt(6)
    v_mfma_f32_16x16x16_bf16 v[36:39], v[146:147], v[240:241], v[36:39]
    v_cvt_pk_bf16_f32 v190, v92, v93
    v_cvt_pk_bf16_f32 v191, v94, v95
    v_mfma_f32_16x16x16_bf16 v[68:71], v[146:147], v[244:245], v[68:71]
    s_add_u32 s82, s81, s41
    buffer_store_dwordx4 v[188:191], v14, s[60:63], s82 offen offset:1024 sc1
    v_mfma_f32_16x16x16_bf16 v[100:103], v[146:147], v[248:249], v[100:103]
    s_waitcnt lgkmcnt(4)
    v_mfma_f32_16x16x32_bf16 v[40:43], v[148:151], v[216:219], 0
    v_mfma_f32_16x16x32_bf16 v[72:75], v[148:151], v[220:223], 0
    v_mfma_f32_16x16x32_bf16 v[104:107], v[148:151], v[224:227], 0
    v_cvt_pk_bf16_f32 v192, v32, v33
    v_cvt_pk_bf16_f32 v193, v34, v35
    s_waitcnt lgkmcnt(1)
    v_mfma_f32_16x16x32_bf16 v[44:47], v[154:157], v[216:219], 0
    v_cvt_pk_bf16_f32 v194, v36, v37
    v_cvt_pk_bf16_f32 v195, v38, v39
    v_mfma_f32_16x16x32_bf16 v[76:79], v[154:157], v[220:223], 0
    s_add_u32 s82, s81, s41
    buffer_store_dwordx4 v[192:195], v14, s[60:63], s82 offen offset:2048 sc1
    v_mfma_f32_16x16x32_bf16 v[108:111], v[154:157], v[224:227], 0
    v_cvt_pk_bf16_f32 v196, v64, v65
    v_cvt_pk_bf16_f32 v197, v66, v67
    v_mfma_f32_16x16x16_bf16 v[40:43], v[152:153], v[240:241], v[40:43]
    v_cvt_pk_bf16_f32 v198, v68, v69
    v_cvt_pk_bf16_f32 v199, v70, v71
    v_mfma_f32_16x16x16_bf16 v[72:75], v[152:153], v[244:245], v[72:75]
    s_add_u32 s82, s81, s41
    buffer_store_dwordx4 v[196:199], v14, s[60:63], s82 offen offset:3072 sc1
    v_mfma_f32_16x16x16_bf16 v[104:107], v[152:153], v[248:249], v[104:107]
    v_cvt_pk_bf16_f32 v200, v96, v97
    v_cvt_pk_bf16_f32 v201, v98, v99
    s_waitcnt lgkmcnt(0)
    v_mfma_f32_16x16x16_bf16 v[44:47], v[158:159], v[240:241], v[44:47]
    v_cvt_pk_bf16_f32 v202, v100, v101
    v_cvt_pk_bf16_f32 v203, v102, v103
    v_mfma_f32_16x16x16_bf16 v[76:79], v[158:159], v[244:245], v[76:79]
    s_add_u32 s82, s81, s42
    buffer_store_dwordx4 v[200:203], v14, s[60:63], s82 offen sc1
    v_mfma_f32_16x16x16_bf16 v[108:111], v[158:159], v[248:249], v[108:111]
    v_cvt_pk_bf16_f32 v204, v40, v41
    v_cvt_pk_bf16_f32 v205, v42, v43
    v_cvt_pk_bf16_f32 v206, v44, v45
    v_cvt_pk_bf16_f32 v207, v46, v47
    s_add_u32 s82, s81, s42
    buffer_store_dwordx4 v[204:207], v14, s[60:63], s82 offen offset:1024 sc1
    v_cvt_pk_bf16_f32 v208, v72, v73
    v_cvt_pk_bf16_f32 v209, v74, v75
    v_cvt_pk_bf16_f32 v210, v76, v77
    v_cvt_pk_bf16_f32 v211, v78, v79
    s_add_u32 s82, s81, s42
    buffer_store_dwordx4 v[208:211], v14, s[60:63], s82 offen offset:2048 sc1
    v_cvt_pk_bf16_f32 v212, v104, v105
    v_cvt_pk_bf16_f32 v213, v106, v107
    v_cvt_pk_bf16_f32 v214, v108, v109
    v_cvt_pk_bf16_f32 v215, v110, v111
    s_add_u32 s82, s81, s42
    buffer_store_dwordx4 v[212:215], v14, s[60:63], s82 offen offset:3072 sc1
    s_waitcnt lgkmcnt(0)
    s_barrier
    ds_read_b64_tr_b16 v[124:125], v13
    ds_read_b64_tr_b16 v[126:127], v13 offset:5120
    ds_read_b64_tr_b16 v[128:129], v15
    ds_read_b64_tr_b16 v[130:131], v15 offset:5120
    ds_read_b64_tr_b16 v[132:133], v13 offset:64
    ds_read_b64_tr_b16 v[134:135], v13 offset:5184
    ds_read_b64_tr_b16 v[136:137], v15 offset:64
    ds_read_b64_tr_b16 v[138:139], v15 offset:5184
    ds_read_b64_tr_b16 v[140:141], v13 offset:128
    ds_read_b64_tr_b16 v[142:143], v13 offset:5248
    ds_read_b64_tr_b16 v[144:145], v15 offset:128
    ds_read_b64_tr_b16 v[146:147], v15 offset:5248
    ds_read_b64_tr_b16 v[148:149], v13 offset:192
    ds_read_b64_tr_b16 v[150:151], v13 offset:5312
    ds_read_b64_tr_b16 v[152:153], v15 offset:192
    ds_read_b64_tr_b16 v[154:155], v15 offset:5312
    ds_read_b64_tr_b16 v[156:157], v12
    ds_read_b64_tr_b16 v[158:159], v12 offset:5120
    s_waitcnt lgkmcnt(8)
    v_mfma_f32_16x16x32_bf16 v[16:19], v[124:127], v[168:171], 0
    v_mfma_f32_16x16x32_bf16 v[52:55], v[124:127], v[172:175], 0
    v_mfma_f32_16x16x32_bf16 v[88:91], v[124:127], v[176:179], 0
    v_mfma_f32_16x16x32_bf16 v[92:95], v[128:131], v[176:179], 0
    ds_read_b64_tr_b16 v[124:125], v13 offset:10240
    v_mfma_f32_16x16x32_bf16 v[56:59], v[128:131], v[172:175], 0
    ds_read_b64_tr_b16 v[126:127], v13 offset:15360
    v_mfma_f32_16x16x32_bf16 v[20:23], v[128:131], v[168:171], 0
    v_mfma_f32_16x16x32_bf16 v[24:27], v[132:135], v[168:171], 0
    ds_read_b64_tr_b16 v[128:129], v15 offset:10240
    v_mfma_f32_16x16x32_bf16 v[60:63], v[132:135], v[172:175], 0
    ds_read_b64_tr_b16 v[130:131], v15 offset:15360
    v_mfma_f32_16x16x32_bf16 v[96:99], v[132:135], v[176:179], 0
    v_mfma_f32_16x16x32_bf16 v[100:103], v[136:139], v[176:179], 0
    ds_read_b64_tr_b16 v[132:133], v13 offset:10304
    v_mfma_f32_16x16x32_bf16 v[64:67], v[136:139], v[172:175], 0
    ds_read_b64_tr_b16 v[134:135], v13 offset:15424
    v_mfma_f32_16x16x32_bf16 v[28:31], v[136:139], v[168:171], 0
    v_mfma_f32_16x16x32_bf16 v[32:35], v[140:143], v[168:171], 0
    ds_read_b64_tr_b16 v[136:137], v15 offset:10304
    v_mfma_f32_16x16x32_bf16 v[68:71], v[140:143], v[172:175], 0
    ds_read_b64_tr_b16 v[138:139], v15 offset:15424
    v_mfma_f32_16x16x32_bf16 v[104:107], v[140:143], v[176:179], 0
    s_waitcnt lgkmcnt(8)
    v_mfma_f32_16x16x32_bf16 v[108:111], v[144:147], v[176:179], 0
    ds_read_b64_tr_b16 v[140:141], v13 offset:10368
    v_mfma_f32_16x16x32_bf16 v[72:75], v[144:147], v[172:175], 0
    ds_read_b64_tr_b16 v[142:143], v13 offset:15488
    v_mfma_f32_16x16x32_bf16 v[36:39], v[144:147], v[168:171], 0
    v_mfma_f32_16x16x32_bf16 v[40:43], v[148:151], v[168:171], 0
    ds_read_b64_tr_b16 v[144:145], v15 offset:10368
    v_mfma_f32_16x16x32_bf16 v[76:79], v[148:151], v[172:175], 0
    ds_read_b64_tr_b16 v[146:147], v15 offset:15488
    v_mfma_f32_16x16x32_bf16 v[112:115], v[148:151], v[176:179], 0
    v_mfma_f32_16x16x32_bf16 v[116:119], v[152:155], v[176:179], 0
    ds_read_b64_tr_b16 v[148:149], v13 offset:10432
    v_mfma_f32_16x16x32_bf16 v[80:83], v[152:155], v[172:175], 0
    ds_read_b64_tr_b16 v[150:151], v13 offset:15552
    v_mfma_f32_16x16x32_bf16 v[44:47], v[152:155], v[168:171], 0
    v_mfma_f32_16x16x32_bf16 v[48:51], v[156:159], v[168:171], 0
    ds_read_b64_tr_b16 v[152:153], v15 offset:10432
    v_mfma_f32_16x16x32_bf16 v[84:87], v[156:159], v[172:175], 0
    ds_read_b64_tr_b16 v[154:155], v15 offset:15552
    v_mfma_f32_16x16x32_bf16 v[120:123], v[156:159], v[176:179], 0
    ds_read_b64_tr_b16 v[156:157], v12 offset:10240
    ds_read_b64_tr_b16 v[158:159], v12 offset:15360
    s_waitcnt vmcnt(0)
    s_mov_b32 exec_lo, s85
    s_mov_b32 exec_hi, 0
    buffer_store_dwordx2 v[8:9], v11, s[60:63], s84 offen sc1
    s_mov_b64 exec, -1
    s_barrier
    s_waitcnt lgkmcnt(8)
    v_mfma_f32_16x16x32_bf16 v[88:91], v[124:127], v[188:191], v[88:91]
    v_mfma_f32_16x16x32_bf16 v[52:55], v[124:127], v[184:187], v[52:55]
    v_mfma_f32_16x16x32_bf16 v[16:19], v[124:127], v[180:183], v[16:19]
    v_mfma_f32_16x16x32_bf16 v[20:23], v[128:131], v[180:183], v[20:23]
    ds_read_b64_tr_b16 v[124:125], v13 offset:20480
    v_mfma_f32_16x16x32_bf16 v[56:59], v[128:131], v[184:187], v[56:59]
    ds_read_b64_tr_b16 v[126:127], v13 offset:25600
    v_mfma_f32_16x16x32_bf16 v[92:95], v[128:131], v[188:191], v[92:95]
    v_mfma_f32_16x16x32_bf16 v[96:99], v[132:135], v[188:191], v[96:99]
    ds_read_b64_tr_b16 v[128:129], v15 offset:20480
    v_mfma_f32_16x16x32_bf16 v[60:63], v[132:135], v[184:187], v[60:63]
    ds_read_b64_tr_b16 v[130:131], v15 offset:25600
    v_mfma_f32_16x16x32_bf16 v[24:27], v[132:135], v[180:183], v[24:27]
    v_mfma_f32_16x16x32_bf16 v[28:31], v[136:139], v[180:183], v[28:31]
    ds_read_b64_tr_b16 v[132:133], v13 offset:20544
    v_mfma_f32_16x16x32_bf16 v[64:67], v[136:139], v[184:187], v[64:67]
    ds_read_b64_tr_b16 v[134:135], v13 offset:25664
    v_mfma_f32_16x16x32_bf16 v[100:103], v[136:139], v[188:191], v[100:103]
    v_mfma_f32_16x16x32_bf16 v[104:107], v[140:143], v[188:191], v[104:107]
    ds_read_b64_tr_b16 v[136:137], v15 offset:20544
    v_mfma_f32_16x16x32_bf16 v[68:71], v[140:143], v[184:187], v[68:71]
    ds_read_b64_tr_b16 v[138:139], v15 offset:25664
    v_mfma_f32_16x16x32_bf16 v[32:35], v[140:143], v[180:183], v[32:35]
    s_waitcnt lgkmcnt(8)
    v_mfma_f32_16x16x32_bf16 v[36:39], v[144:147], v[180:183], v[36:39]
    ds_read_b64_tr_b16 v[140:141], v13 offset:20608
    v_mfma_f32_16x16x32_bf16 v[72:75], v[144:147], v[184:187], v[72:75]
    ds_read_b64_tr_b16 v[142:143], v13 offset:25728
    v_mfma_f32_16x16x32_bf16 v[108:111], v[144:147], v[188:191], v[108:111]
    v_mfma_f32_16x16x32_bf16 v[112:115], v[148:151], v[188:191], v[112:115]
    ds_read_b64_tr_b16 v[144:145], v15 offset:20608
    v_mfma_f32_16x16x32_bf16 v[76:79], v[148:151], v[184:187], v[76:79]
    ds_read_b64_tr_b16 v[146:147], v15 offset:25728
    v_mfma_f32_16x16x32_bf16 v[40:43], v[148:151], v[180:183], v[40:43]
    v_mfma_f32_16x16x32_bf16 v[44:47], v[152:155], v[180:183], v[44:47]
    ds_read_b64_tr_b16 v[148:149], v13 offset:20672
    v_mfma_f32_16x16x32_bf16 v[80:83], v[152:155], v[184:187], v[80:83]
    ds_read_b64_tr_b16 v[150:151], v13 offset:25792
    v_mfma_f32_16x16x32_bf16 v[116:119], v[152:155], v[188:191], v[116:119]
    v_mfma_f32_16x16x32_bf16 v[120:123], v[156:159], v[188:191], v[120:123]
    ds_read_b64_tr_b16 v[152:153], v15 offset:20672
    v_mfma_f32_16x16x32_bf16 v[84:87], v[156:159], v[184:187], v[84:87]
    ds_read_b64_tr_b16 v[154:155], v15 offset:25792
    v_mfma_f32_16x16x32_bf16 v[48:51], v[156:159], v[180:183], v[48:51]
    s_waitcnt lgkmcnt(8)
    v_mfma_f32_16x16x32_bf16 v[16:19], v[124:127], v[192:195], v[16:19]
    ds_read_b64_tr_b16 v[156:157], v12 offset:20480
    v_mfma_f32_16x16x32_bf16 v[52:55], v[124:127], v[196:199], v[52:55]
    ds_read_b64_tr_b16 v[158:159], v12 offset:25600
    v_mfma_f32_16x16x32_bf16 v[88:91], v[124:127], v[200:203], v[88:91]
    v_mfma_f32_16x16x32_bf16 v[92:95], v[128:131], v[200:203], v[92:95]
    ds_read_b64_tr_b16 v[124:125], v13 offset:30720
    v_mfma_f32_16x16x32_bf16 v[56:59], v[128:131], v[196:199], v[56:59]
    ds_read_b64_tr_b16 v[126:127], v13 offset:35840
    v_mfma_f32_16x16x32_bf16 v[20:23], v[128:131], v[192:195], v[20:23]
    v_mfma_f32_16x16x32_bf16 v[24:27], v[132:135], v[192:195], v[24:27]
    ds_read_b64_tr_b16 v[128:129], v15 offset:30720
    v_mfma_f32_16x16x32_bf16 v[60:63], v[132:135], v[196:199], v[60:63]
    ds_read_b64_tr_b16 v[130:131], v15 offset:35840
    v_mfma_f32_16x16x32_bf16 v[96:99], v[132:135], v[200:203], v[96:99]
    v_mfma_f32_16x16x32_bf16 v[100:103], v[136:139], v[200:203], v[100:103]
    ds_read_b64_tr_b16 v[132:133], v13 offset:30784
    v_mfma_f32_16x16x32_bf16 v[64:67], v[136:139], v[196:199], v[64:67]
    ds_read_b64_tr_b16 v[134:135], v13 offset:35904
    v_mfma_f32_16x16x32_bf16 v[28:31], v[136:139], v[192:195], v[28:31]
    s_waitcnt lgkmcnt(8)
    v_mfma_f32_16x16x32_bf16 v[32:35], v[140:143], v[192:195], v[32:35]
    ds_read_b64_tr_b16 v[136:137], v15 offset:30784
    v_mfma_f32_16x16x32_bf16 v[68:71], v[140:143], v[196:199], v[68:71]
    ds_read_b64_tr_b16 v[138:139], v15 offset:35904
    v_mfma_f32_16x16x32_bf16 v[104:107], v[140:143], v[200:203], v[104:107]
    v_mfma_f32_16x16x32_bf16 v[108:111], v[144:147], v[200:203], v[108:111]
    ds_read_b64_tr_b16 v[140:141], v13 offset:30848
    v_mfma_f32_16x16x32_bf16 v[72:75], v[144:147], v[196:199], v[72:75]
    ds_read_b64_tr_b16 v[142:143], v13 offset:35968
    v_mfma_f32_16x16x32_bf16 v[36:39], v[144:147], v[192:195], v[36:39]
    v_mfma_f32_16x16x32_bf16 v[40:43], v[148:151], v[192:195], v[40:43]
    ds_read_b64_tr_b16 v[144:145], v15 offset:30848
    v_mfma_f32_16x16x32_bf16 v[76:79], v[148:151], v[196:199], v[76:79]
    ds_read_b64_tr_b16 v[146:147], v15 offset:35968
    v_mfma_f32_16x16x32_bf16 v[112:115], v[148:151], v[200:203], v[112:115]
    v_mfma_f32_16x16x32_bf16 v[116:119], v[152:155], v[200:203], v[116:119]
    ds_read_b64_tr_b16 v[148:149], v13 offset:30912
    v_mfma_f32_16x16x32_bf16 v[80:83], v[152:155], v[196:199], v[80:83]
    ds_read_b64_tr_b16 v[150:151], v13 offset:36032
    v_mfma_f32_16x16x32_bf16 v[44:47], v[152:155], v[192:195], v[44:47]
    s_waitcnt lgkmcnt(8)
    v_mfma_f32_16x16x32_bf16 v[48:51], v[156:159], v[192:195], v[48:51]
    ds_read_b64_tr_b16 v[152:153], v15 offset:30912
    v_mfma_f32_16x16x32_bf16 v[84:87], v[156:159], v[196:199], v[84:87]
    ds_read_b64_tr_b16 v[154:155], v15 offset:36032
    v_mfma_f32_16x16x32_bf16 v[120:123], v[156:159], v[200:203], v[120:123]
    v_mfma_f32_16x16x32_bf16 v[88:91], v[124:127], v[212:215], v[88:91]
    ds_read_b64_tr_b16 v[156:157], v12 offset:30720
    v_mfma_f32_16x16x32_bf16 v[52:55], v[124:127], v[208:211], v[52:55]
    ds_read_b64_tr_b16 v[158:159], v12 offset:35840
    v_mfma_f32_16x16x32_bf16 v[16:19], v[124:127], v[204:207], v[16:19]
    v_mfma_f32_16x16x32_bf16 v[20:23], v[128:131], v[204:207], v[20:23]
    v_mfma_f32_16x16x32_bf16 v[56:59], v[128:131], v[208:211], v[56:59]
    v_mfma_f32_16x16x32_bf16 v[92:95], v[128:131], v[212:215], v[92:95]
    v_mfma_f32_16x16x32_bf16 v[96:99], v[132:135], v[212:215], v[96:99]
    v_mfma_f32_16x16x32_bf16 v[60:63], v[132:135], v[208:211], v[60:63]
    v_mfma_f32_16x16x32_bf16 v[24:27], v[132:135], v[204:207], v[24:27]
    s_waitcnt lgkmcnt(8)
    v_mfma_f32_16x16x32_bf16 v[28:31], v[136:139], v[204:207], v[28:31]
    v_mfma_f32_16x16x32_bf16 v[64:67], v[136:139], v[208:211], v[64:67]
    v_mfma_f32_16x16x32_bf16 v[100:103], v[136:139], v[212:215], v[100:103]
    v_mfma_f32_16x16x32_bf16 v[104:107], v[140:143], v[212:215], v[104:107]
    v_mfma_f32_16x16x32_bf16 v[68:71], v[140:143], v[208:211], v[68:71]
    v_mfma_f32_16x16x32_bf16 v[32:35], v[140:143], v[204:207], v[32:35]
    s_waitcnt lgkmcnt(6)
    v_mfma_f32_16x16x32_bf16 v[36:39], v[144:147], v[204:207], v[36:39]
    v_mfma_f32_16x16x32_bf16 v[72:75], v[144:147], v[208:211], v[72:75]
    v_mfma_f32_16x16x32_bf16 v[108:111], v[144:147], v[212:215], v[108:111]
    s_waitcnt lgkmcnt(4)
    v_mfma_f32_16x16x32_bf16 v[112:115], v[148:151], v[212:215], v[112:115]
    v_mfma_f32_16x16x32_bf16 v[76:79], v[148:151], v[208:211], v[76:79]
    v_mfma_f32_16x16x32_bf16 v[40:43], v[148:151], v[204:207], v[40:43]
    s_waitcnt lgkmcnt(2)
    v_mfma_f32_16x16x32_bf16 v[44:47], v[152:155], v[204:207], v[44:47]
    v_mfma_f32_16x16x32_bf16 v[80:83], v[152:155], v[208:211], v[80:83]
    v_mfma_f32_16x16x32_bf16 v[116:119], v[152:155], v[212:215], v[116:119]
    s_waitcnt lgkmcnt(0)
    v_mfma_f32_16x16x32_bf16 v[120:123], v[156:159], v[212:215], v[120:123]
    v_mfma_f32_16x16x32_bf16 v[84:87], v[156:159], v[208:211], v[84:87]
    v_mfma_f32_16x16x32_bf16 v[48:51], v[156:159], v[204:207], v[48:51]
    s_barrier
    v_subrev_u32 v13, 122880, v13
    v_subrev_u32 v15, 122880, v15
    v_subrev_u32 v12, 122880, v12
    ds_read_b64_tr_b16 v[124:125], v13
    ds_read_b64_tr_b16 v[126:127], v13 offset:5120
    ds_read_b64_tr_b16 v[128:129], v15
    ds_read_b64_tr_b16 v[130:131], v15 offset:5120
    ds_read_b64_tr_b16 v[132:133], v13 offset:64
    ds_read_b64_tr_b16 v[134:135], v13 offset:5184
    ds_read_b64_tr_b16 v[136:137], v15 offset:64
    ds_read_b64_tr_b16 v[138:139], v15 offset:5184
    ds_read_b64_tr_b16 v[140:141], v13 offset:128
    ds_read_b64_tr_b16 v[142:143], v13 offset:5248
    ds_read_b64_tr_b16 v[144:145], v15 offset:128
    ds_read_b64_tr_b16 v[146:147], v15 offset:5248
    ds_read_b64_tr_b16 v[148:149], v13 offset:192
    ds_read_b64_tr_b16 v[150:151], v13 offset:5312
    ds_read_b64_tr_b16 v[152:153], v15 offset:192
    ds_read_b64_tr_b16 v[154:155], v15 offset:5312
    ds_read_b64_tr_b16 v[156:157], v12
    ds_read_b64_tr_b16 v[158:159], v12 offset:5120
    s_cmp_le_u32 s98, 0
    s_cselect_b32 s81, 1, 0
    s_lshl_b32 s81, s81, 15
    s_add_u32 s81, s81, s80
    s_mov_b32 exec_lo, s86
    s_mov_b32 exec_hi, 0
    s_mov_b32 s76, 0
Lpoll_7:
    buffer_load_dwordx2 v[6:7], v11, s[60:63], s84 offen sc1
    s_add_u32 s76, s76, 1
    s_cmp_gt_u32 s76, 131072
    s_waitcnt vmcnt(0)
    s_cbranch_scc1 Lpollx_8
    v_cmp_ne_u64 vcc, v[6:7], v[8:9]
    s_cbranch_vccnz Lpoll_7
Lpollx_8:
    s_mov_b64 exec, -1
    s_add_u32 s82, s81, s40
    buffer_load_dwordx4 v[216:219], v14, s[60:63], s82 offen sc1
    s_add_u32 s82, s81, s40
    buffer_load_dwordx4 v[220:223], v14, s[60:63], s82 offen offset:1024 sc1
    s_add_u32 s82, s81, s40
    buffer_load_dwordx4 v[224:227], v14, s[60:63], s82 offen offset:2048 sc1
    s_add_u32 s82, s81, s40
    buffer_load_dwordx4 v[228:231], v14, s[60:63], s82 offen offset:3072 sc1
    s_add_u32 s82, s81, s41
    buffer_load_dwordx4 v[232:235], v14, s[60:63], s82 offen sc1
    s_add_u32 s82, s81, s41
    buffer_load_dwordx4 v[236:239], v14, s[60:63], s82 offen offset:1024 sc1
    s_add_u32 s82, s81, s41
    buffer_load_dwordx4 v[240:243], v14, s[60:63], s82 offen offset:2048 sc1
    s_add_u32 s82, s81, s41
    buffer_load_dwordx4 v[244:247], v14, s[60:63], s82 offen offset:3072 sc1
    s_add_u32 s82, s81, s42
    buffer_load_dwordx4 v[248:251], v14, s[60:63], s82 offen sc1
    s_add_u32 s82, s81, s42
    buffer_load_dwordx4 v[252:255], v14, s[60:63], s82 offen offset:1024 sc1
    s_add_u32 s82, s81, s42
    buffer_load_dwordx4 v[160:163], v14, s[60:63], s82 offen offset:2048 sc1
    s_add_u32 s82, s81, s42
    buffer_load_dwordx4 v[164:167], v14, s[60:63], s82 offen offset:3072 sc1
    s_waitcnt vmcnt(11) lgkmcnt(8)
    v_mfma_f32_16x16x32_bf16 v[16:19], v[124:127], v[216:219], v[16:19]
    s_cmp_le_u32 s98, 1
    s_cselect_b32 s81, 2, 1
    s_lshl_b32 s81, s81, 15
    s_waitcnt vmcnt(10)
    v_mfma_f32_16x16x32_bf16 v[52:55], v[124:127], v[220:223], v[52:55]
    s_add_u32 s81, s81, s80
    s_add_u32 s82, s81, s40
    s_waitcnt vmcnt(9)
    v_mfma_f32_16x16x32_bf16 v[88:91], v[124:127], v[224:227], v[88:91]
    buffer_load_dwordx4 v[168:171], v14, s[60:63], s82 offen sc1
    v_mfma_f32_16x16x32_bf16 v[92:95], v[128:131], v[224:227], v[92:95]
    ds_read_b64_tr_b16 v[124:125], v13 offset:10240
    v_mfma_f32_16x16x32_bf16 v[56:59], v[128:131], v[220:223], v[56:59]
    ds_read_b64_tr_b16 v[126:127], v13 offset:15360
    v_mfma_f32_16x16x32_bf16 v[20:23], v[128:131], v[216:219], v[20:23]
    v_mfma_f32_16x16x32_bf16 v[24:27], v[132:135], v[216:219], v[24:27]
    ds_read_b64_tr_b16 v[128:129], v15 offset:10240
    v_mfma_f32_16x16x32_bf16 v[60:63], v[132:135], v[220:223], v[60:63]
    ds_read_b64_tr_b16 v[130:131], v15 offset:15360
    v_mfma_f32_16x16x32_bf16 v[96:99], v[132:135], v[224:227], v[96:99]
    v_mfma_f32_16x16x32_bf16 v[100:103], v[136:139], v[224:227], v[100:103]
    ds_read_b64_tr_b16 v[132:133], v13 offset:10304
    ds_read_b64_tr_b16 v[134:135], v13 offset:15424
    v_mfma_f32_16x16x32_bf16 v[64:67], v[136:139], v[220:223], v[64:67]
    s_add_u32 s82, s81, s40
    v_mfma_f32_16x16x32_bf16 v[28:31], v[136:139], v[216:219], v[28:31]
    buffer_load_dwordx4 v[172:175], v14, s[60:63], s82 offen offset:1024 sc1
    v_mfma_f32_16x16x32_bf16 v[32:35], v[140:143], v[216:219], v[32:35]
    ds_read_b64_tr_b16 v[136:137], v15 offset:10304
    v_mfma_f32_16x16x32_bf16 v[68:71], v[140:143], v[220:223], v[68:71]
    ds_read_b64_tr_b16 v[138:139], v15 offset:15424
    v_mfma_f32_16x16x32_bf16 v[104:107], v[140:143], v[224:227], v[104:107]
    s_waitcnt lgkmcnt(8)
    v_mfma_f32_16x16x32_bf16 v[108:111], v[144:147], v[224:227], v[108:111]
    ds_read_b64_tr_b16 v[140:141], v13 offset:10368
    v_mfma_f32_16x16x32_bf16 v[72:75], v[144:147], v[220:223], v[72:75]
    ds_read_b64_tr_b16 v[142:143], v13 offset:15488
    v_mfma_f32_16x16x32_bf16 v[36:39], v[144:147], v[216:219], v[36:39]
    v_mfma_f32_16x16x32_bf16 v[40:43], v[148:151], v[216:219], v[40:43]
    ds_read_b64_tr_b16 v[144:145], v15 offset:10368
    ds_read_b64_tr_b16 v[146:147], v15 offset:15488
    v_mfma_f32_16x16x32_bf16 v[76:79], v[148:151], v[220:223], v[76:79]
    s_add_u32 s82, s81, s40
    v_mfma_f32_16x16x32_bf16 v[112:115], v[148:151], v[224:227], v[112:115]
    buffer_load_dwordx4 v[176:179], v14, s[60:63], s82 offen offset:2048 sc1
    v_mfma_f32_16x16x32_bf16 v[116:119], v[152:155], v[224:227], v[116:119]
    ds_read_b64_tr_b16 v[148:149], v13 offset:10432
    v_mfma_f32_16x16x32_bf16 v[80:83], v[152:155], v[220:223], v[80:83]
    ds_read_b64_tr_b16 v[150:151], v13 offset:15552
    v_mfma_f32_16x16x32_bf16 v[44:47], v[152:155], v[216:219], v[44:47]
    v_mfma_f32_16x16x32_bf16 v[48:51], v[156:159], v[216:219], v[48:51]
    ds_read_b64_tr_b16 v[152:153], v15 offset:10432
    v_mfma_f32_16x16x32_bf16 v[84:87], v[156:159], v[220:223], v[84:87]
    ds_read_b64_tr_b16 v[154:155], v15 offset:15552
    v_mfma_f32_16x16x32_bf16 v[120:123], v[156:159], v[224:227], v[120:123]
    s_waitcnt vmcnt(9) lgkmcnt(8)
    v_mfma_f32_16x16x32_bf16 v[88:91], v[124:127], v[236:239], v[88:91]
    ds_read_b64_tr_b16 v[156:157], v12 offset:10240
    ds_read_b64_tr_b16 v[158:159], v12 offset:15360
    v_mfma_f32_16x16x32_bf16 v[52:55], v[124:127], v[232:235], v[52:55]
    s_add_u32 s82, s81, s40
    v_mfma_f32_16x16x32_bf16 v[16:19], v[124:127], v[228:231], v[16:19]
    buffer_load_dwordx4 v[180:183], v14, s[60:63], s82 offen offset:3072 sc1
    v_mfma_f32_16x16x32_bf16 v[20:23], v[128:131], v[228:231], v[20:23]
    ds_read_b64_tr_b16 v[124:125], v13 offset:20480
    v_mfma_f32_16x16x32_bf16 v[56:59], v[128:131], v[232:235], v[56:59]
    ds_read_b64_tr_b16 v[126:127], v13 offset:25600
    v_mfma_f32_16x16x32_bf16 v[92:95], v[128:131], v[236:239], v[92:95]
    v_mfma_f32_16x16x32_bf16 v[96:99], v[132:135], v[236:239], v[96:99]
    ds_read_b64_tr_b16 v[128:129], v15 offset:20480
    v_mfma_f32_16x16x32_bf16 v[60:63], v[132:135], v[232:235], v[60:63]
    ds_read_b64_tr_b16 v[130:131], v15 offset:25600
    v_mfma_f32_16x16x32_bf16 v[24:27], v[132:135], v[228:231], v[24:27]
    v_mfma_f32_16x16x32_bf16 v[28:31], v[136:139], v[228:231], v[28:31]
    ds_read_b64_tr_b16 v[132:133], v13 offset:20544
    ds_read_b64_tr_b16 v[134:135], v13 offset:25664
    v_mfma_f32_16x16x32_bf16 v[64:67], v[136:139], v[232:235], v[64:67]
    s_add_u32 s82, s81, s41
    v_mfma_f32_16x16x32_bf16 v[100:103], v[136:139], v[236:239], v[100:103]
    buffer_load_dwordx4 v[184:187], v14, s[60:63], s82 offen sc1
    s_waitcnt lgkmcnt(8)
    v_mfma_f32_16x16x32_bf16 v[104:107], v[140:143], v[236:239], v[104:107]
    ds_read_b64_tr_b16 v[136:137], v15 offset:20544
    v_mfma_f32_16x16x32_bf16 v[68:71], v[140:143], v[232:235], v[68:71]
    ds_read_b64_tr_b16 v[138:139], v15 offset:25664
    v_mfma_f32_16x16x32_bf16 v[32:35], v[140:143], v[228:231], v[32:35]
    v_mfma_f32_16x16x32_bf16 v[36:39], v[144:147], v[228:231], v[36:39]
    ds_read_b64_tr_b16 v[140:141], v13 offset:20608
    v_mfma_f32_16x16x32_bf16 v[72:75], v[144:147], v[232:235], v[72:75]
    ds_read_b64_tr_b16 v[142:143], v13 offset:25728
    v_mfma_f32_16x16x32_bf16 v[108:111], v[144:147], v[236:239], v[108:111]
    v_mfma_f32_16x16x32_bf16 v[112:115], v[148:151], v[236:239], v[112:115]
    ds_read_b64_tr_b16 v[144:145], v15 offset:20608
    ds_read_b64_tr_b16 v[146:147], v15 offset:25728
    v_mfma_f32_16x16x32_bf16 v[76:79], v[148:151], v[232:235], v[76:79]
    s_add_u32 s82, s81, s41
    v_mfma_f32_16x16x32_bf16 v[40:43], v[148:151], v[228:231], v[40:43]
    buffer_load_dwordx4 v[188:191], v14, s[60:63], s82 offen offset:1024 sc1
    v_mfma_f32_16x16x32_bf16 v[44:47], v[152:155], v[228:231], v[44:47]
    ds_read_b64_tr_b16 v[148:149], v13 offset:20672
    v_mfma_f32_16x16x32_bf16 v[80:83], v[152:155], v[232:235], v[80:83]
    ds_read_b64_tr_b16 v[150:151], v13 offset:25792
    v_mfma_f32_16x16x32_bf16 v[116:119], v[152:155], v[236:239], v[116:119]
    s_waitcnt lgkmcnt(8)
    v_mfma_f32_16x16x32_bf16 v[120:123], v[156:159], v[236:239], v[120:123]
    ds_read_b64_tr_b16 v[152:153], v15 offset:20672
    v_mfma_f32_16x16x32_bf16 v[84:87], v[156:159], v[232:235], v[84:87]
    ds_read_b64_tr_b16 v[154:155], v15 offset:25792
    v_mfma_f32_16x16x32_bf16 v[48:51], v[156:159], v[228:231], v[48:51]
    s_waitcnt vmcnt(11)
    v_mfma_f32_16x16x32_bf16 v[16:19], v[124:127], v[240:243], v[16:19]
    ds_read_b64_tr_b16 v[156:157], v12 offset:20480
    ds_read_b64_tr_b16 v[158:159], v12 offset:25600
    s_add_u32 s82, s81, s41
    s_waitcnt vmcnt(10)
    v_mfma_f32_16x16x32_bf16 v[52:55], v[124:127], v[244:247], v[52:55]
    buffer_load_dwordx4 v[192:195], v14, s[60:63], s82 offen offset:2048 sc1
    v_lshrrev_b32 v4, 2, v1
    v_mul_u32_u24 v4, 2304, v4
    s_waitcnt vmcnt(10)
    v_mfma_f32_16x16x32_bf16 v[88:91], v[124:127], v[248:251], v[88:91]
    v_bfe_u32 v5, v1, 1, 1
    v_mad_u32_u24 v4, v5, s74, v4
    v_and_b32 v5, 1, v1
    v_mfma_f32_16x16x32_bf16 v[92:95], v[128:131], v[248:251], v[92:95]
    ds_read_b64_tr_b16 v[124:125], v13 offset:30720
    ds_read_b64_tr_b16 v[126:127], v13 offset:35840
    v_lshl_add_u32 v4, v5, 4, v4
    v_mfma_f32_16x16x32_bf16 v[56:59], v[128:131], v[244:247], v[56:59]
    v_lshlrev_b32 v3, 7, v1
    v_lshlrev_b32 v2, 4, v1
    v_lshl_add_u32 v2, s72, 10, v2
    v_mfma_f32_16x16x32_bf16 v[20:23], v[128:131], v[240:243], v[20:23]
    v_add_u32 v2, 122880, v2
    v_lshrrev_b32 v5, 1, v1
    v_lshrrev_b32 v5, v5, s53
    v_mfma_f32_16x16x32_bf16 v[24:27], v[132:135], v[240:243], v[24:27]
    ds_read_b64_tr_b16 v[128:129], v15 offset:30720
    ds_read_b64_tr_b16 v[130:131], v15 offset:35840
    v_and_b32 v5, 1, v5
    v_mfma_f32_16x16x32_bf16 v[60:63], v[132:135], v[244:247], v[60:63]
    v_lshl_add_u32 v3, v5, 13, v3
    s_xor_b32 s97, s97, 0xff
    v_mfma_f32_16x16x32_bf16 v[96:99], v[132:135], v[248:251], v[96:99]
    s_lshl_b32 s55, s90, 3
    s_add_u32 s55, s55, s96
    s_waitcnt lgkmcnt(8)
    v_mfma_f32_16x16x32_bf16 v[100:103], v[136:139], v[248:251], v[100:103]
    ds_read_b64_tr_b16 v[132:133], v13 offset:30784
    ds_read_b64_tr_b16 v[134:135], v13 offset:35904
    v_mfma_f32_16x16x32_bf16 v[64:67], v[136:139], v[244:247], v[64:67]
    s_lshl_b32 s76, s90, 7
    s_add_u32 s96, s96, s76
    v_mfma_f32_16x16x32_bf16 v[28:31], v[136:139], v[240:243], v[28:31]
    s_add_u32 s96, s96, s52
    s_add_u32 s82, s81, s41
    v_mfma_f32_16x16x32_bf16 v[32:35], v[140:143], v[240:243], v[32:35]
    ds_read_b64_tr_b16 v[136:137], v15 offset:30784
    ds_read_b64_tr_b16 v[138:139], v15 offset:35904
    v_mfma_f32_16x16x32_bf16 v[68:71], v[140:143], v[244:247], v[68:71]
    buffer_load_dwordx4 v[196:199], v14, s[60:63], s82 offen offset:3072 sc1
    v_mfma_f32_16x16x32_bf16 v[104:107], v[140:143], v[248:251], v[104:107]
    v_mfma_f32_16x16x32_bf16 v[108:111], v[144:147], v[248:251], v[108:111]
    ds_read_b64_tr_b16 v[140:141], v13 offset:30848
    v_mfma_f32_16x16x32_bf16 v[72:75], v[144:147], v[244:247], v[72:75]
    ds_read_b64_tr_b16 v[142:143], v13 offset:35968
    v_mfma_f32_16x16x32_bf16 v[36:39], v[144:147], v[240:243], v[36:39]
    v_mfma_f32_16x16x32_bf16 v[40:43], v[148:151], v[240:243], v[40:43]
    ds_read_b64_tr_b16 v[144:145], v15 offset:30848
    ds_read_b64_tr_b16 v[146:147], v15 offset:35968
    v_mfma_f32_16x16x32_bf16 v[76:79], v[148:151], v[244:247], v[76:79]
    s_add_u32 s82, s81, s42
    v_mfma_f32_16x16x32_bf16 v[112:115], v[148:151], v[248:251], v[112:115]
    buffer_load_dwordx4 v[200:203], v14, s[60:63], s82 offen sc1
    s_waitcnt lgkmcnt(8)
    v_mfma_f32_16x16x32_bf16 v[116:119], v[152:155], v[248:251], v[116:119]
    ds_read_b64_tr_b16 v[148:149], v13 offset:30912
    v_mfma_f32_16x16x32_bf16 v[80:83], v[152:155], v[244:247], v[80:83]
    ds_read_b64_tr_b16 v[150:151], v13 offset:36032
    v_mfma_f32_16x16x32_bf16 v[44:47], v[152:155], v[240:243], v[44:47]
    v_mfma_f32_16x16x32_bf16 v[48:51], v[156:159], v[240:243], v[48:51]
    ds_read_b64_tr_b16 v[152:153], v15 offset:30912
    v_mfma_f32_16x16x32_bf16 v[84:87], v[156:159], v[244:247], v[84:87]
    ds_read_b64_tr_b16 v[154:155], v15 offset:36032
    v_mfma_f32_16x16x32_bf16 v[120:123], v[156:159], v[248:251], v[120:123]
    s_waitcnt vmcnt(9)
    v_mfma_f32_16x16x32_bf16 v[88:91], v[124:127], v[164:167], v[88:91]
    ds_read_b64_tr_b16 v[156:157], v12 offset:30720
    ds_read_b64_tr_b16 v[158:159], v12 offset:35840
    v_mfma_f32_16x16x32_bf16 v[52:55], v[124:127], v[160:163], v[52:55]
    s_add_u32 s82, s81, s42
    v_mfma_f32_16x16x32_bf16 v[16:19], v[124:127], v[252:255], v[16:19]
    buffer_load_dwordx4 v[204:207], v14, s[60:63], s82 offen offset:1024 sc1
    s_barrier
    v_add_u32 v13, 40960, v13
    v_add_u32 v15, 40960, v15
    v_add_u32 v12, 40960, v12
    v_mfma_f32_16x16x32_bf16 v[20:23], v[128:131], v[252:255], v[20:23]
    ds_read_b64_tr_b16 v[124:125], v13
    v_mfma_f32_16x16x32_bf16 v[56:59], v[128:131], v[160:163], v[56:59]
    ds_read_b64_tr_b16 v[126:127], v13 offset:5120
    v_mfma_f32_16x16x32_bf16 v[92:95], v[128:131], v[164:167], v[92:95]
    s_waitcnt lgkmcnt(8)
    v_mfma_f32_16x16x32_bf16 v[96:99], v[132:135], v[164:167], v[96:99]
    ds_read_b64_tr_b16 v[128:129], v15
    v_mfma_f32_16x16x32_bf16 v[60:63], v[132:135], v[160:163], v[60:63]
    ds_read_b64_tr_b16 v[130:131], v15 offset:5120
    v_mfma_f32_16x16x32_bf16 v[24:27], v[132:135], v[252:255], v[24:27]
    v_mfma_f32_16x16x32_bf16 v[28:31], v[136:139], v[252:255], v[28:31]
    ds_read_b64_tr_b16 v[132:133], v13 offset:64
    ds_read_b64_tr_b16 v[134:135], v13 offset:5184
    v_mfma_f32_16x16x32_bf16 v[64:67], v[136:139], v[160:163], v[64:67]
    s_add_u32 s82, s81, s42
    v_mfma_f32_16x16x32_bf16 v[100:103], v[136:139], v[164:167], v[100:103]
    buffer_load_dwordx4 v[208:211], v14, s[60:63], s82 offen offset:2048 sc1
    v_mfma_f32_16x16x32_bf16 v[104:107], v[140:143], v[164:167], v[104:107]
    ds_read_b64_tr_b16 v[136:137], v15 offset:64
    v_mfma_f32_16x16x32_bf16 v[68:71], v[140:143], v[160:163], v[68:71]
    ds_read_b64_tr_b16 v[138:139], v15 offset:5184
    v_mfma_f32_16x16x32_bf16 v[32:35], v[140:143], v[252:255], v[32:35]
    v_mfma_f32_16x16x32_bf16 v[36:39], v[144:147], v[252:255], v[36:39]
    ds_read_b64_tr_b16 v[140:141], v13 offset:128
    v_mfma_f32_16x16x32_bf16 v[72:75], v[144:147], v[160:163], v[72:75]
    ds_read_b64_tr_b16 v[142:143], v13 offset:5248
    v_mfma_f32_16x16x32_bf16 v[108:111], v[144:147], v[164:167], v[108:111]
    s_waitcnt lgkmcnt(8)
    v_mfma_f32_16x16x32_bf16 v[112:115], v[148:151], v[164:167], v[112:115]
    ds_read_b64_tr_b16 v[144:145], v15 offset:128
    ds_read_b64_tr_b16 v[146:147], v15 offset:5248
    v_mfma_f32_16x16x32_bf16 v[76:79], v[148:151], v[160:163], v[76:79]
    s_add_u32 s82, s81, s42
    v_mfma_f32_16x16x32_bf16 v[40:43], v[148:151], v[252:255], v[40:43]
    buffer_load_dwordx4 v[212:215], v14, s[60:63], s82 offen offset:3072 sc1
    v_mfma_f32_16x16x32_bf16 v[44:47], v[152:155], v[252:255], v[44:47]
    ds_read_b64_tr_b16 v[148:149], v13 offset:192
    v_mfma_f32_16x16x32_bf16 v[80:83], v[152:155], v[160:163], v[80:83]
    ds_read_b64_tr_b16 v[150:151], v13 offset:5312
    v_mfma_f32_16x16x32_bf16 v[116:119], v[152:155], v[164:167], v[116:119]
    v_mfma_f32_16x16x32_bf16 v[120:123], v[156:159], v[164:167], v[120:123]
    ds_read_b64_tr_b16 v[152:153], v15 offset:192
    v_mfma_f32_16x16x32_bf16 v[84:87], v[156:159], v[160:163], v[84:87]
    ds_read_b64_tr_b16 v[154:155], v15 offset:5312
    v_mfma_f32_16x16x32_bf16 v[48:51], v[156:159], v[252:255], v[48:51]
    s_waitcnt vmcnt(11)
    v_mfma_f32_16x16x32_bf16 v[16:19], v[124:127], v[168:171], v[16:19]
    ds_read_b64_tr_b16 v[156:157], v12
    ds_read_b64_tr_b16 v[158:159], v12 offset:5120
    s_waitcnt vmcnt(10)
    v_mfma_f32_16x16x32_bf16 v[52:55], v[124:127], v[172:175], v[52:55]
    s_cmp_le_u32 s98, 2
    s_cselect_b32 s81, 3, 2
    s_lshl_b32 s81, s81, 15
    s_waitcnt vmcnt(9)
    v_mfma_f32_16x16x32_bf16 v[88:91], v[124:127], v[176:179], v[88:91]
    s_add_u32 s81, s81, s80
    s_add_u32 s82, s81, s40
    s_waitcnt lgkmcnt(8)
    v_mfma_f32_16x16x32_bf16 v[92:95], v[128:131], v[176:179], v[92:95]
    ds_read_b64_tr_b16 v[124:125], v13 offset:10240
    ds_read_b64_tr_b16 v[126:127], v13 offset:15360
    v_mfma_f32_16x16x32_bf16 v[56:59], v[128:131], v[172:175], v[56:59]
    buffer_load_dwordx4 v[216:219], v14, s[60:63], s82 offen sc1
    s_add_u32 s82, s81, s40
    v_mfma_f32_16x16x32_bf16 v[20:23], v[128:131], v[168:171], v[20:23]
    buffer_load_dwordx4 v[220:223], v14, s[60:63], s82 offen offset:1024 sc1
    v_mfma_f32_16x16x32_bf16 v[24:27], v[132:135], v[168:171], v[24:27]
    ds_read_b64_tr_b16 v[128:129], v15 offset:10240
    ds_read_b64_tr_b16 v[130:131], v15 offset:15360
    v_mfma_f32_16x16x32_bf16 v[60:63], v[132:135], v[172:175], v[60:63]
    s_add_u32 s82, s81, s40
    v_mfma_f32_16x16x32_bf16 v[96:99], v[132:135], v[176:179], v[96:99]
    buffer_load_dwordx4 v[224:227], v14, s[60:63], s82 offen offset:2048 sc1
    v_mfma_f32_16x16x32_bf16 v[100:103], v[136:139], v[176:179], v[100:103]
    ds_read_b64_tr_b16 v[132:133], v13 offset:10304
    ds_read_b64_tr_b16 v[134:135], v13 offset:15424
    v_mfma_f32_16x16x32_bf16 v[64:67], v[136:139], v[172:175], v[64:67]
    s_add_u32 s82, s81, s40
    v_mfma_f32_16x16x32_bf16 v[28:31], v[136:139], v[168:171], v[28:31]
    buffer_load_dwordx4 v[228:231], v14, s[60:63], s82 offen offset:3072 sc1
    v_mfma_f32_16x16x32_bf16 v[32:35], v[140:143], v[168:171], v[32:35]
    ds_read_b64_tr_b16 v[136:137], v15 offset:10304
    ds_read_b64_tr_b16 v[138:139], v15 offset:15424
    v_mfma_f32_16x16x32_bf16 v[68:71], v[140:143], v[172:175], v[68:71]
    s_add_u32 s82, s81, s41
    v_mfma_f32_16x16x32_bf16 v[104:107], v[140:143], v[176:179], v[104:107]
    buffer_load_dwordx4 v[232:235], v14, s[60:63], s82 offen sc1
    s_waitcnt lgkmcnt(8)
    v_mfma_f32_16x16x32_bf16 v[108:111], v[144:147], v[176:179], v[108:111]
    ds_read_b64_tr_b16 v[140:141], v13 offset:10368
    ds_read_b64_tr_b16 v[142:143], v13 offset:15488
    v_mfma_f32_16x16x32_bf16 v[72:75], v[144:147], v[172:175], v[72:75]
    s_add_u32 s82, s81, s41
    v_mfma_f32_16x16x32_bf16 v[36:39], v[144:147], v[168:171], v[36:39]
    buffer_load_dwordx4 v[236:239], v14, s[60:63], s82 offen offset:1024 sc1
    v_mfma_f32_16x16x32_bf16 v[40:43], v[148:151], v[168:171], v[40:43]
    ds_read_b64_tr_b16 v[144:145], v15 offset:10368
    v_mfma_f32_16x16x32_bf16 v[76:79], v[148:151], v[172:175], v[76:79]
    ds_read_b64_tr_b16 v[146:147], v15 offset:15488
    v_mfma_f32_16x16x32_bf16 v[112:115], v[148:151], v[176:179], v[112:115]
    v_mfma_f32_16x16x32_bf16 v[116:119], v[152:155], v[176:179], v[116:119]
    ds_read_b64_tr_b16 v[148:149], v13 offset:10432
    v_mfma_f32_16x16x32_bf16 v[80:83], v[152:155], v[172:175], v[80:83]
    ds_read_b64_tr_b16 v[150:151], v13 offset:15552
    v_mfma_f32_16x16x32_bf16 v[44:47], v[152:155], v[168:171], v[44:47]
    v_mfma_f32_16x16x32_bf16 v[48:51], v[156:159], v[168:171], v[48:51]
    ds_read_b64_tr_b16 v[152:153], v15 offset:10432
    v_mfma_f32_16x16x32_bf16 v[84:87], v[156:159], v[172:175], v[84:87]
    ds_read_b64_tr_b16 v[154:155], v15 offset:15552
    v_mfma_f32_16x16x32_bf16 v[120:123], v[156:159], v[176:179], v[120:123]
    s_waitcnt vmcnt(12) lgkmcnt(8)
    v_mfma_f32_16x16x32_bf16 v[88:91], v[124:127], v[188:191], v[88:91]
    ds_read_b64_tr_b16 v[156:157], v12 offset:10240
    ds_read_b64_tr_b16 v[158:159], v12 offset:15360
    v_mfma_f32_16x16x32_bf16 v[52:55], v[124:127], v[184:187], v[52:55]
    s_add_u32 s82, s81, s41
    v_mfma_f32_16x16x32_bf16 v[16:19], v[124:127], v[180:183], v[16:19]
    buffer_load_dwordx4 v[240:243], v14, s[60:63], s82 offen offset:2048 sc1
    v_mfma_f32_16x16x32_bf16 v[20:23], v[128:131], v[180:183], v[20:23]
    ds_read_b64_tr_b16 v[124:125], v13 offset:20480
    ds_read_b64_tr_b16 v[126:127], v13 offset:25600
    v_mfma_f32_16x16x32_bf16 v[56:59], v[128:131], v[184:187], v[56:59]
    s_add_u32 s82, s81, s41
    v_mfma_f32_16x16x32_bf16 v[92:95], v[128:131], v[188:191], v[92:95]
    buffer_load_dwordx4 v[244:247], v14, s[60:63], s82 offen offset:3072 sc1
    v_mfma_f32_16x16x32_bf16 v[96:99], v[132:135], v[188:191], v[96:99]
    ds_read_b64_tr_b16 v[128:129], v15 offset:20480
    ds_read_b64_tr_b16 v[130:131], v15 offset:25600
    v_mfma_f32_16x16x32_bf16 v[60:63], v[132:135], v[184:187], v[60:63]
    s_add_u32 s82, s81, s42
    v_mfma_f32_16x16x32_bf16 v[24:27], v[132:135], v[180:183], v[24:27]
    buffer_load_dwordx4 v[248:251], v14, s[60:63], s82 offen sc1
    v_mfma_f32_16x16x32_bf16 v[28:31], v[136:139], v[180:183], v[28:31]
    ds_read_b64_tr_b16 v[132:133], v13 offset:20544
    ds_read_b64_tr_b16 v[134:135], v13 offset:25664
    v_mfma_f32_16x16x32_bf16 v[64:67], v[136:139], v[184:187], v[64:67]
    s_add_u32 s82, s81, s42
    v_mfma_f32_16x16x32_bf16 v[100:103], v[136:139], v[188:191], v[100:103]
    buffer_load_dwordx4 v[252:255], v14, s[60:63], s82 offen offset:1024 sc1
    s_waitcnt lgkmcnt(8)
    v_mfma_f32_16x16x32_bf16 v[104:107], v[140:143], v[188:191], v[104:107]
    ds_read_b64_tr_b16 v[136:137], v15 offset:20544
    ds_read_b64_tr_b16 v[138:139], v15 offset:25664
    v_mfma_f32_16x16x32_bf16 v[68:71], v[140:143], v[184:187], v[68:71]
    s_add_u32 s82, s81, s42
    v_mfma_f32_16x16x32_bf16 v[32:35], v[140:143], v[180:183], v[32:35]
    buffer_load_dwordx4 v[160:163], v14, s[60:63], s82 offen offset:2048 sc1
    v_mfma_f32_16x16x32_bf16 v[36:39], v[144:147], v[180:183], v[36:39]
    ds_read_b64_tr_b16 v[140:141], v13 offset:20608
    ds_read_b64_tr_b16 v[142:143], v13 offset:25728
    v_mfma_f32_16x16x32_bf16 v[72:75], v[144:147], v[184:187], v[72:75]
    s_add_u32 s82, s81, s42
    v_mfma_f32_16x16x32_bf16 v[108:111], v[144:147], v[188:191], v[108:111]
    buffer_load_dwordx4 v[164:167], v14, s[60:63], s82 offen offset:3072 sc1
    v_mfma_f32_16x16x32_bf16 v[112:115], v[148:151], v[188:191], v[112:115]
    ds_read_b64_tr_b16 v[144:145], v15 offset:20608
    v_mfma_f32_16x16x32_bf16 v[76:79], v[148:151], v[184:187], v[76:79]
    ds_read_b64_tr_b16 v[146:147], v15 offset:25728
    v_mfma_f32_16x16x32_bf16 v[40:43], v[148:151], v[180:183], v[40:43]
    v_mfma_f32_16x16x32_bf16 v[44:47], v[152:155], v[180:183], v[44:47]
    ds_read_b64_tr_b16 v[148:149], v13 offset:20672
    v_mfma_f32_16x16x32_bf16 v[80:83], v[152:155], v[184:187], v[80:83]
    ds_read_b64_tr_b16 v[150:151], v13 offset:25792
    v_mfma_f32_16x16x32_bf16 v[116:119], v[152:155], v[188:191], v[116:119]
    s_waitcnt lgkmcnt(8)
    v_mfma_f32_16x16x32_bf16 v[120:123], v[156:159], v[188:191], v[120:123]
    ds_read_b64_tr_b16 v[152:153], v15 offset:20672
    v_mfma_f32_16x16x32_bf16 v[84:87], v[156:159], v[184:187], v[84:87]
    ds_read_b64_tr_b16 v[154:155], v15 offset:25792
    v_mfma_f32_16x16x32_bf16 v[48:51], v[156:159], v[180:183], v[48:51]
    s_waitcnt vmcnt(17)
    v_mfma_f32_16x16x32_bf16 v[16:19], v[124:127], v[192:195], v[16:19]
    ds_read_b64_tr_b16 v[156:157], v12 offset:20480
    s_waitcnt vmcnt(16)
    v_mfma_f32_16x16x32_bf16 v[52:55], v[124:127], v[196:199], v[52:55]
    ds_read_b64_tr_b16 v[158:159], v12 offset:25600
    s_waitcnt vmcnt(15)
    v_mfma_f32_16x16x32_bf16 v[88:91], v[124:127], v[200:203], v[88:91]
    v_mfma_f32_16x16x32_bf16 v[92:95], v[128:131], v[200:203], v[92:95]
    ds_read_b64_tr_b16 v[124:125], v13 offset:30720
    v_mfma_f32_16x16x32_bf16 v[56:59], v[128:131], v[196:199], v[56:59]
    ds_read_b64_tr_b16 v[126:127], v13 offset:35840
    v_mfma_f32_16x16x32_bf16 v[20:23], v[128:131], v[192:195], v[20:23]
    v_mfma_f32_16x16x32_bf16 v[24:27], v[132:135], v[192:195], v[24:27]
    ds_read_b64_tr_b16 v[128:129], v15 offset:30720
    v_mfma_f32_16x16x32_bf16 v[60:63], v[132:135], v[196:199], v[60:63]
    ds_read_b64_tr_b16 v[130:131], v15 offset:35840
    v_mfma_f32_16x16x32_bf16 v[96:99], v[132:135], v[200:203], v[96:99]
    s_waitcnt lgkmcnt(8)
    v_mfma_f32_16x16x32_bf16 v[100:103], v[136:139], v[200:203], v[100:103]
    ds_read_b64_tr_b16 v[132:133], v13 offset:30784
    v_mfma_f32_16x16x32_bf16 v[64:67], v[136:139], v[196:199], v[64:67]
    ds_read_b64_tr_b16 v[134:135], v13 offset:35904
    v_mfma_f32_16x16x32_bf16 v[28:31], v[136:139], v[192:195], v[28:31]
    v_mfma_f32_16x16x32_bf16 v[32:35], v[140:143], v[192:195], v[32:35]
    ds_read_b64_tr_b16 v[136:137], v15 offset:30784
    v_mfma_f32_16x16x32_bf16 v[68:71], v[140:143], v[196:199], v[68:71]
    ds_read_b64_tr_b16 v[138:139], v15 offset:35904
    v_mfma_f32_16x16x32_bf16 v[104:107], v[140:143], v[200:203], v[104:107]
    v_mfma_f32_16x16x32_bf16 v[108:111], v[144:147], v[200:203], v[108:111]
    ds_read_b64_tr_b16 v[140:141], v13 offset:30848
    v_mfma_f32_16x16x32_bf16 v[72:75], v[144:147], v[196:199], v[72:75]
    ds_read_b64_tr_b16 v[142:143], v13 offset:35968
    v_mfma_f32_16x16x32_bf16 v[36:39], v[144:147], v[192:195], v[36:39]
    v_mfma_f32_16x16x32_bf16 v[40:43], v[148:151], v[192:195], v[40:43]
    ds_read_b64_tr_b16 v[144:145], v15 offset:30848
    v_mfma_f32_16x16x32_bf16 v[76:79], v[148:151], v[196:199], v[76:79]
    ds_read_b64_tr_b16 v[146:147], v15 offset:35968
    v_mfma_f32_16x16x32_bf16 v[112:115], v[148:151], v[200:203], v[112:115]
    s_waitcnt lgkmcnt(8)
    v_mfma_f32_16x16x32_bf16 v[116:119], v[152:155], v[200:203], v[116:119]
    ds_read_b64_tr_b16 v[148:149], v13 offset:30912
    v_mfma_f32_16x16x32_bf16 v[80:83], v[152:155], v[196:199], v[80:83]
    ds_read_b64_tr_b16 v[150:151], v13 offset:36032
    v_mfma_f32_16x16x32_bf16 v[44:47], v[152:155], v[192:195], v[44:47]
    v_mfma_f32_16x16x32_bf16 v[48:51], v[156:159], v[192:195], v[48:51]
    ds_read_b64_tr_b16 v[152:153], v15 offset:30912
    v_mfma_f32_16x16x32_bf16 v[84:87], v[156:159], v[196:199], v[84:87]
    ds_read_b64_tr_b16 v[154:155], v15 offset:36032
    v_mfma_f32_16x16x32_bf16 v[120:123], v[156:159], v[200:203], v[120:123]
    s_waitcnt vmcnt(12)
    v_mfma_f32_16x16x32_bf16 v[88:91], v[124:127], v[212:215], v[88:91]
    ds_read_b64_tr_b16 v[156:157], v12 offset:30720
    v_mfma_f32_16x16x32_bf16 v[52:55], v[124:127], v[208:211], v[52:55]
    ds_read_b64_tr_b16 v[158:159], v12 offset:35840
    v_mfma_f32_16x16x32_bf16 v[16:19], v[124:127], v[204:207], v[16:19]
    s_barrier
    v_add_u32 v13, 40960, v13
    v_add_u32 v15, 40960, v15
    v_add_u32 v12, 40960, v12
    v_mfma_f32_16x16x32_bf16 v[20:23], v[128:131], v[204:207], v[20:23]
    ds_read_b64_tr_b16 v[124:125], v13
    v_mfma_f32_16x16x32_bf16 v[56:59], v[128:131], v[208:211], v[56:59]
    ds_read_b64_tr_b16 v[126:127], v13 offset:5120
    v_mfma_f32_16x16x32_bf16 v[92:95], v[128:131], v[212:215], v[92:95]
    s_waitcnt lgkmcnt(8)
    v_mfma_f32_16x16x32_bf16 v[96:99], v[132:135], v[212:215], v[96:99]
    ds_read_b64_tr_b16 v[128:129], v13 offset:10240
    v_mfma_f32_16x16x32_bf16 v[60:63], v[132:135], v[208:211], v[60:63]
    ds_read_b64_tr_b16 v[130:131], v13 offset:15360
    v_mfma_f32_16x16x32_bf16 v[24:27], v[132:135], v[204:207], v[24:27]
    v_mfma_f32_16x16x32_bf16 v[28:31], v[136:139], v[204:207], v[28:31]
    ds_read_b64_tr_b16 v[132:133], v13 offset:20480
    v_mfma_f32_16x16x32_bf16 v[64:67], v[136:139], v[208:211], v[64:67]
    ds_read_b64_tr_b16 v[134:135], v13 offset:25600
    v_mfma_f32_16x16x32_bf16 v[100:103], v[136:139], v[212:215], v[100:103]
    v_mfma_f32_16x16x32_bf16 v[104:107], v[140:143], v[212:215], v[104:107]
    ds_read_b64_tr_b16 v[136:137], v13 offset:30720
    v_mfma_f32_16x16x32_bf16 v[68:71], v[140:143], v[208:211], v[68:71]
    ds_read_b64_tr_b16 v[138:139], v13 offset:35840
    v_mfma_f32_16x16x32_bf16 v[32:35], v[140:143], v[204:207], v[32:35]
    v_mfma_f32_16x16x32_bf16 v[36:39], v[144:147], v[204:207], v[36:39]
    ds_read_b64_tr_b16 v[140:141], v15
    v_mfma_f32_16x16x32_bf16 v[72:75], v[144:147], v[208:211], v[72:75]
    ds_read_b64_tr_b16 v[142:143], v15 offset:5120
    v_mfma_f32_16x16x32_bf16 v[108:111], v[144:147], v[212:215], v[108:111]
    s_waitcnt lgkmcnt(8)
    v_mfma_f32_16x16x32_bf16 v[112:115], v[148:151], v[212:215], v[112:115]
    ds_read_b64_tr_b16 v[144:145], v15 offset:10240
    v_mfma_f32_16x16x32_bf16 v[76:79], v[148:151], v[208:211], v[76:79]
    ds_read_b64_tr_b16 v[146:147], v15 offset:15360
    v_mfma_f32_16x16x32_bf16 v[40:43], v[148:151], v[204:207], v[40:43]
    v_mfma_f32_16x16x32_bf16 v[44:47], v[152:155], v[204:207], v[44:47]
    ds_read_b64_tr_b16 v[148:149], v15 offset:20480
    v_mfma_f32_16x16x32_bf16 v[80:83], v[152:155], v[208:211], v[80:83]
    ds_read_b64_tr_b16 v[150:151], v15 offset:25600
    v_mfma_f32_16x16x32_bf16 v[116:119], v[152:155], v[212:215], v[116:119]
    v_mfma_f32_16x16x32_bf16 v[120:123], v[156:159], v[212:215], v[120:123]
    ds_read_b64_tr_b16 v[152:153], v15 offset:30720
    v_mfma_f32_16x16x32_bf16 v[84:87], v[156:159], v[208:211], v[84:87]
    ds_read_b64_tr_b16 v[154:155], v15 offset:35840
    v_mfma_f32_16x16x32_bf16 v[48:51], v[156:159], v[204:207], v[48:51]
    s_waitcnt vmcnt(11)
    v_mfma_f32_16x16x32_bf16 v[16:19], v[124:127], v[216:219], v[16:19]
    ds_read_b64_tr_b16 v[156:157], v13 offset:64
    s_waitcnt vmcnt(10)
    v_mfma_f32_16x16x32_bf16 v[52:55], v[124:127], v[220:223], v[52:55]
    ds_read_b64_tr_b16 v[158:159], v13 offset:5184
    s_waitcnt vmcnt(9)
    v_mfma_f32_16x16x32_bf16 v[88:91], v[124:127], v[224:227], v[88:91]
    s_waitcnt vmcnt(6) lgkmcnt(8)
    v_mfma_f32_16x16x32_bf16 v[88:91], v[128:131], v[236:239], v[88:91]
    ds_read_b64_tr_b16 v[124:125], v13 offset:10304
    v_mfma_f32_16x16x32_bf16 v[52:55], v[128:131], v[232:235], v[52:55]
    ds_read_b64_tr_b16 v[126:127], v13 offset:15424
    v_mfma_f32_16x16x32_bf16 v[16:19], v[128:131], v[228:231], v[16:19]
    s_waitcnt vmcnt(5)
    v_mfma_f32_16x16x32_bf16 v[16:19], v[132:135], v[240:243], v[16:19]
    ds_read_b64_tr_b16 v[128:129], v13 offset:20544
    s_waitcnt vmcnt(4)
    v_mfma_f32_16x16x32_bf16 v[52:55], v[132:135], v[244:247], v[52:55]
    ds_read_b64_tr_b16 v[130:131], v13 offset:25664
    s_waitcnt vmcnt(3)
    v_mfma_f32_16x16x32_bf16 v[88:91], v[132:135], v[248:251], v[88:91]
    s_waitcnt vmcnt(0)
    v_mfma_f32_16x16x32_bf16 v[88:91], v[136:139], v[164:167], v[88:91]
    ds_read_b64_tr_b16 v[132:133], v13 offset:30784
    v_mfma_f32_16x16x32_bf16 v[52:55], v[136:139], v[160:163], v[52:55]
    ds_read_b64_tr_b16 v[134:135], v13 offset:35904
    v_mfma_f32_16x16x32_bf16 v[16:19], v[136:139], v[252:255], v[16:19]
    v_mfma_f32_16x16x32_bf16 v[20:23], v[140:143], v[216:219], v[20:23]
    ds_read_b64_tr_b16 v[136:137], v15 offset:64
    v_mfma_f32_16x16x32_bf16 v[56:59], v[140:143], v[220:223], v[56:59]
    ds_read_b64_tr_b16 v[138:139], v15 offset:5184
    v_mfma_f32_16x16x32_bf16 v[92:95], v[140:143], v[224:227], v[92:95]
    s_waitcnt lgkmcnt(8)
    v_mfma_f32_16x16x32_bf16 v[92:95], v[144:147], v[236:239], v[92:95]
    ds_read_b64_tr_b16 v[140:141], v15 offset:10304
    v_mfma_f32_16x16x32_bf16 v[56:59], v[144:147], v[232:235], v[56:59]
    ds_read_b64_tr_b16 v[142:143], v15 offset:15424
    v_mfma_f32_16x16x32_bf16 v[20:23], v[144:147], v[228:231], v[20:23]
    v_mfma_f32_16x16x32_bf16 v[20:23], v[148:151], v[240:243], v[20:23]
    ds_read_b64_tr_b16 v[144:145], v15 offset:20544
    v_mfma_f32_16x16x32_bf16 v[56:59], v[148:151], v[244:247], v[56:59]
    ds_read_b64_tr_b16 v[146:147], v15 offset:25664
    v_mfma_f32_16x16x32_bf16 v[92:95], v[148:151], v[248:251], v[92:95]
    v_mfma_f32_16x16x32_bf16 v[92:95], v[152:155], v[164:167], v[92:95]
    ds_read_b64_tr_b16 v[148:149], v15 offset:30784
    v_mfma_f32_16x16x32_bf16 v[56:59], v[152:155], v[160:163], v[56:59]
    ds_read_b64_tr_b16 v[150:151], v15 offset:35904
    v_mfma_f32_16x16x32_bf16 v[20:23], v[152:155], v[252:255], v[20:23]
    v_mfma_f32_16x16x32_bf16 v[24:27], v[156:159], v[216:219], v[24:27]
    ds_read_b64_tr_b16 v[152:153], v13 offset:128
    v_mfma_f32_16x16x32_bf16 v[60:63], v[156:159], v[220:223], v[60:63]
    ds_read_b64_tr_b16 v[154:155], v13 offset:5248
    v_mfma_f32_16x16x32_bf16 v[96:99], v[156:159], v[224:227], v[96:99]
    s_waitcnt lgkmcnt(8)
    v_mfma_f32_16x16x32_bf16 v[96:99], v[124:127], v[236:239], v[96:99]
    ds_read_b64_tr_b16 v[156:157], v13 offset:10368
    ds_read_b64_tr_b16 v[158:159], v13 offset:15488
    v_cvt_pk_bf16_f32 v16, v16, v17
    v_mfma_f32_16x16x32_bf16 v[60:63], v[124:127], v[232:235], v[60:63]
    v_cvt_pk_bf16_f32 v17, v18, v19
    v_cvt_pk_bf16_f32 v18, v20, v21
    v_cvt_pk_bf16_f32 v19, v22, v23
    v_mfma_f32_16x16x32_bf16 v[24:27], v[124:127], v[228:231], v[24:27]
    s_add_u32 s82, s44, 0
    s_cmp_eq_u32 s90, 0
    s_cbranch_scc1 Lown_9
    buffer_store_dwordx4 v[16:19], v14, s[60:63], s82 offen sc1
Lownb_10:
    v_cvt_pk_bf16_f32 v52, v52, v53
    v_mfma_f32_16x16x32_bf16 v[24:27], v[128:131], v[240:243], v[24:27]
    ds_read_b64_tr_b16 v[124:125], v13 offset:20608
    ds_read_b64_tr_b16 v[126:127], v13 offset:25728
    v_cvt_pk_bf16_f32 v53, v54, v55
    v_mfma_f32_16x16x32_bf16 v[60:63], v[128:131], v[244:247], v[60:63]
    v_cvt_pk_bf16_f32 v54, v56, v57
    v_cvt_pk_bf16_f32 v55, v58, v59
    s_add_u32 s82, s44, 16384
    v_mfma_f32_16x16x32_bf16 v[96:99], v[128:131], v[248:251], v[96:99]
    s_cmp_eq_u32 s90, 1
    s_cbranch_scc1 Lown_11
    buffer_store_dwordx4 v[52:55], v14, s[60:63], s82 offen sc1
Lownb_12:
    v_cvt_pk_bf16_f32 v88, v88, v89
    v_mfma_f32_16x16x32_bf16 v[96:99], v[132:135], v[164:167], v[96:99]
    ds_read_b64_tr_b16 v[128:129], v13 offset:30848
    ds_read_b64_tr_b16 v[130:131], v13 offset:35968
    v_mfma_f32_16x16x32_bf16 v[60:63], v[132:135], v[160:163], v[60:63]
    v_cvt_pk_bf16_f32 v89, v90, v91
    v_cvt_pk_bf16_f32 v90, v92, v93
    v_mfma_f32_16x16x32_bf16 v[24:27], v[132:135], v[252:255], v[24:27]
    v_cvt_pk_bf16_f32 v91, v94, v95
    s_add_u32 s82, s45, 32768
    v_mfma_f32_16x16x32_bf16 v[28:31], v[136:139], v[216:219], v[28:31]
    ds_read_b64_tr_b16 v[132:133], v15 offset:128
    ds_read_b64_tr_b16 v[134:135], v15 offset:5248
    v_mfma_f32_16x16x32_bf16 v[64:67], v[136:139], v[220:223], v[64:67]
    s_cmp_eq_u32 s90, 2
    s_cbranch_scc1 Lown_13
    buffer_store_dwordx4 v[88:91], v14, s[60:63], s82 offen sc1
Lownb_14:
    v_mfma_f32_16x16x32_bf16 v[100:103], v[136:139], v[224:227], v[100:103]
    s_waitcnt lgkmcnt(8)
    v_mfma_f32_16x16x32_bf16 v[100:103], v[140:143], v[236:239], v[100:103]
    ds_read_b64_tr_b16 v[136:137], v15 offset:10368
    v_mfma_f32_16x16x32_bf16 v[64:67], v[140:143], v[232:235], v[64:67]
    ds_read_b64_tr_b16 v[138:139], v15 offset:15488
    v_mfma_f32_16x16x32_bf16 v[28:31], v[140:143], v[228:231], v[28:31]
    v_mfma_f32_16x16x32_bf16 v[28:31], v[144:147], v[240:243], v[28:31]
    ds_read_b64_tr_b16 v[140:141], v15 offset:20608
    v_mfma_f32_16x16x32_bf16 v[64:67], v[144:147], v[244:247], v[64:67]
    ds_read_b64_tr_b16 v[142:143], v15 offset:25728
    v_mfma_f32_16x16x32_bf16 v[100:103], v[144:147], v[248:251], v[100:103]
    v_mfma_f32_16x16x32_bf16 v[100:103], v[148:151], v[164:167], v[100:103]
    ds_read_b64_tr_b16 v[144:145], v15 offset:30848
    v_mfma_f32_16x16x32_bf16 v[64:67], v[148:151], v[160:163], v[64:67]
    ds_read_b64_tr_b16 v[146:147], v15 offset:35968
    v_mfma_f32_16x16x32_bf16 v[28:31], v[148:151], v[252:255], v[28:31]
    v_mfma_f32_16x16x32_bf16 v[32:35], v[152:155], v[216:219], v[32:35]
    ds_read_b64_tr_b16 v[148:149], v13 offset:192
    v_mfma_f32_16x16x32_bf16 v[68:71], v[152:155], v[220:223], v[68:71]
    ds_read_b64_tr_b16 v[150:151], v13 offset:5312
    v_mfma_f32_16x16x32_bf16 v[104:107], v[152:155], v[224:227], v[104:107]
    s_waitcnt lgkmcnt(8)
    v_mfma_f32_16x16x32_bf16 v[104:107], v[156:159], v[236:239], v[104:107]
    ds_read_b64_tr_b16 v[152:153], v13 offset:10432
    ds_read_b64_tr_b16 v[154:155], v13 offset:15552
    v_cvt_pk_bf16_f32 v24, v24, v25
    v_mfma_f32_16x16x32_bf16 v[68:71], v[156:159], v[232:235], v[68:71]
    v_cvt_pk_bf16_f32 v25, v26, v27
    v_cvt_pk_bf16_f32 v26, v28, v29
    v_cvt_pk_bf16_f32 v27, v30, v31
    v_mfma_f32_16x16x32_bf16 v[32:35], v[156:159], v[228:231], v[32:35]
    s_add_u32 s82, s45, 49152
    s_cmp_eq_u32 s90, 3
    s_cbranch_scc1 Lown_15
    buffer_store_dwordx4 v[24:27], v14, s[60:63], s82 offen sc1
Lownb_16:
    v_cvt_pk_bf16_f32 v60, v60, v61
    v_mfma_f32_16x16x32_bf16 v[32:35], v[124:127], v[240:243], v[32:35]
    ds_read_b64_tr_b16 v[156:157], v13 offset:20672
    ds_read_b64_tr_b16 v[158:159], v13 offset:25792
    v_cvt_pk_bf16_f32 v61, v62, v63
    v_mfma_f32_16x16x32_bf16 v[68:71], v[124:127], v[244:247], v[68:71]
    v_cvt_pk_bf16_f32 v62, v64, v65
    v_cvt_pk_bf16_f32 v63, v66, v67
    s_add_u32 s82, s46, 65536
    v_mfma_f32_16x16x32_bf16 v[104:107], v[124:127], v[248:251], v[104:107]
    s_cmp_eq_u32 s90, 4
    s_cbranch_scc1 Lown_17
    buffer_store_dwordx4 v[60:63], v14, s[60:63], s82 offen sc1
Lownb_18:
    v_cvt_pk_bf16_f32 v96, v96, v97
    v_mfma_f32_16x16x32_bf16 v[104:107], v[128:131], v[164:167], v[104:107]
    ds_read_b64_tr_b16 v[124:125], v13 offset:30912
    ds_read_b64_tr_b16 v[126:127], v13 offset:36032
    v_mfma_f32_16x16x32_bf16 v[68:71], v[128:131], v[160:163], v[68:71]
    v_cvt_pk_bf16_f32 v97, v98, v99
    v_cvt_pk_bf16_f32 v98, v100, v101
    v_mfma_f32_16x16x32_bf16 v[32:35], v[128:131], v[252:255], v[32:35]
    v_cvt_pk_bf16_f32 v99, v102, v103
    s_add_u32 s82, s46, 81920
    v_mfma_f32_16x16x32_bf16 v[36:39], v[132:135], v[216:219], v[36:39]
    ds_read_b64_tr_b16 v[128:129], v15 offset:192
    ds_read_b64_tr_b16 v[130:131], v15 offset:5312
    v_mfma_f32_16x16x32_bf16 v[72:75], v[132:135], v[220:223], v[72:75]
    s_cmp_eq_u32 s90, 5
    s_cbranch_scc1 Lown_19
    buffer_store_dwordx4 v[96:99], v14, s[60:63], s82 offen sc1
Lownb_20:
    v_mfma_f32_16x16x32_bf16 v[108:111], v[132:135], v[224:227], v[108:111]
    s_waitcnt lgkmcnt(8)
    v_mfma_f32_16x16x32_bf16 v[108:111], v[136:139], v[236:239], v[108:111]
    ds_read_b64_tr_b16 v[132:133], v15 offset:10432
    v_mfma_f32_16x16x32_bf16 v[72:75], v[136:139], v[232:235], v[72:75]
    ds_read_b64_tr_b16 v[134:135], v15 offset:15552
    v_mfma_f32_16x16x32_bf16 v[36:39], v[136:139], v[228:231], v[36:39]
    v_mfma_f32_16x16x32_bf16 v[36:39], v[140:143], v[240:243], v[36:39]
    ds_read_b64_tr_b16 v[136:137], v15 offset:20672
    v_mfma_f32_16x16x32_bf16 v[72:75], v[140:143], v[244:247], v[72:75]
    ds_read_b64_tr_b16 v[138:139], v15 offset:25792
    v_mfma_f32_16x16x32_bf16 v[108:111], v[140:143], v[248:251], v[108:111]
    v_mfma_f32_16x16x32_bf16 v[108:111], v[144:147], v[164:167], v[108:111]
    ds_read_b64_tr_b16 v[140:141], v15 offset:30912
    v_mfma_f32_16x16x32_bf16 v[72:75], v[144:147], v[160:163], v[72:75]
    ds_read_b64_tr_b16 v[142:143], v15 offset:36032
    v_mfma_f32_16x16x32_bf16 v[36:39], v[144:147], v[252:255], v[36:39]
    v_mfma_f32_16x16x32_bf16 v[40:43], v[148:151], v[216:219], v[40:43]
    ds_read_b64_tr_b16 v[144:145], v12
    v_mfma_f32_16x16x32_bf16 v[76:79], v[148:151], v[220:223], v[76:79]
    ds_read_b64_tr_b16 v[146:147], v12 offset:5120
    v_mfma_f32_16x16x32_bf16 v[112:115], v[148:151], v[224:227], v[112:115]
    s_waitcnt lgkmcnt(8)
    v_mfma_f32_16x16x32_bf16 v[112:115], v[152:155], v[236:239], v[112:115]
    ds_read_b64_tr_b16 v[148:149], v12 offset:10240
    ds_read_b64_tr_b16 v[150:151], v12 offset:15360
    v_cvt_pk_bf16_f32 v32, v32, v33
    v_mfma_f32_16x16x32_bf16 v[76:79], v[152:155], v[232:235], v[76:79]
    v_cvt_pk_bf16_f32 v33, v34, v35
    v_cvt_pk_bf16_f32 v34, v36, v37
    v_cvt_pk_bf16_f32 v35, v38, v39
    v_mfma_f32_16x16x32_bf16 v[40:43], v[152:155], v[228:231], v[40:43]
    s_add_u32 s82, s47, 98304
    s_cmp_eq_u32 s90, 6
    s_cbranch_scc1 Lown_21
    buffer_store_dwordx4 v[32:35], v14, s[60:63], s82 offen sc1
Lownb_22:
    v_cvt_pk_bf16_f32 v68, v68, v69
    v_mfma_f32_16x16x32_bf16 v[40:43], v[156:159], v[240:243], v[40:43]
    ds_read_b64_tr_b16 v[152:153], v12 offset:20480
    ds_read_b64_tr_b16 v[154:155], v12 offset:25600
    v_cvt_pk_bf16_f32 v69, v70, v71
    v_mfma_f32_16x16x32_bf16 v[76:79], v[156:159], v[244:247], v[76:79]
    v_cvt_pk_bf16_f32 v70, v72, v73
    v_cvt_pk_bf16_f32 v71, v74, v75
    s_add_u32 s82, s47, 114688
    v_mfma_f32_16x16x32_bf16 v[112:115], v[156:159], v[248:251], v[112:115]
    s_cmp_eq_u32 s90, 7
    s_cbranch_scc1 Lown_23
    buffer_store_dwordx4 v[68:71], v14, s[60:63], s82 offen sc1
Lownb_24:
    v_cvt_pk_bf16_f32 v104, v104, v105
    v_mfma_f32_16x16x32_bf16 v[112:115], v[124:127], v[164:167], v[112:115]
    ds_read_b64_tr_b16 v[156:157], v12 offset:30720
    ds_read_b64_tr_b16 v[158:159], v12 offset:35840
    v_mfma_f32_16x16x32_bf16 v[76:79], v[124:127], v[160:163], v[76:79]
    v_cvt_pk_bf16_f32 v105, v106, v107
    v_cvt_pk_bf16_f32 v106, v108, v109
    v_mfma_f32_16x16x32_bf16 v[40:43], v[124:127], v[252:255], v[40:43]
    v_cvt_pk_bf16_f32 v107, v110, v111
    s_add_u32 s82, s44, 131072
    v_mfma_f32_16x16x32_bf16 v[44:47], v[128:131], v[216:219], v[44:47]
    s_cmp_eq_u32 s90, 0
    s_cbranch_scc1 Lown_25
    buffer_store_dwordx4 v[104:107], v14, s[60:63], s82 offen sc1
Lownb_26:
    v_mfma_f32_16x16x32_bf16 v[80:83], v[128:131], v[220:223], v[80:83]
    v_mfma_f32_16x16x32_bf16 v[116:119], v[128:131], v[224:227], v[116:119]
    s_waitcnt lgkmcnt(8)
    v_mfma_f32_16x16x32_bf16 v[116:119], v[132:135], v[236:239], v[116:119]
    v_mfma_f32_16x16x32_bf16 v[80:83], v[132:135], v[232:235], v[80:83]
    v_mfma_f32_16x16x32_bf16 v[44:47], v[132:135], v[228:231], v[44:47]
    v_mfma_f32_16x16x32_bf16 v[44:47], v[136:139], v[240:243], v[44:47]
    v_mfma_f32_16x16x32_bf16 v[80:83], v[136:139], v[244:247], v[80:83]
    v_mfma_f32_16x16x32_bf16 v[116:119], v[136:139], v[248:251], v[116:119]
    v_mfma_f32_16x16x32_bf16 v[116:119], v[140:143], v[164:167], v[116:119]
    v_mfma_f32_16x16x32_bf16 v[80:83], v[140:143], v[160:163], v[80:83]
    v_mfma_f32_16x16x32_bf16 v[44:47], v[140:143], v[252:255], v[44:47]
    s_waitcnt lgkmcnt(6)
    v_mfma_f32_16x16x32_bf16 v[48:51], v[144:147], v[216:219], v[48:51]
    v_mfma_f32_16x16x32_bf16 v[84:87], v[144:147], v[220:223], v[84:87]
    v_mfma_f32_16x16x32_bf16 v[120:123], v[144:147], v[224:227], v[120:123]
    s_waitcnt lgkmcnt(4)
    v_mfma_f32_16x16x32_bf16 v[120:123], v[148:151], v[236:239], v[120:123]
    v_cvt_pk_bf16_f32 v40, v40, v41
    v_cvt_pk_bf16_f32 v41, v42, v43
    v_cvt_pk_bf16_f32 v42, v44, v45
    v_mfma_f32_16x16x32_bf16 v[84:87], v[148:151], v[232:235], v[84:87]
    v_cvt_pk_bf16_f32 v43, v46, v47
    s_add_u32 s82, s44, 147456
    s_cmp_eq_u32 s90, 1
    s_cbranch_scc1 Lown_27
    buffer_store_dwordx4 v[40:43], v14, s[60:63], s82 offen sc1
Lownb_28:
    v_mfma_f32_16x16x32_bf16 v[48:51], v[148:151], v[228:231], v[48:51]
    v_cvt_pk_bf16_f32 v76, v76, v77
    v_cvt_pk_bf16_f32 v77, v78, v79
    v_cvt_pk_bf16_f32 v78, v80, v81
    s_waitcnt lgkmcnt(2)
    v_mfma_f32_16x16x32_bf16 v[48:51], v[152:155], v[240:243], v[48:51]
    v_cvt_pk_bf16_f32 v79, v82, v83
    s_add_u32 s82, s45, 163840
    s_cmp_eq_u32 s90, 2
    s_cbranch_scc1 Lown_29
    buffer_store_dwordx4 v[76:79], v14, s[60:63], s82 offen sc1
Lownb_30:
    v_mfma_f32_16x16x32_bf16 v[84:87], v[152:155], v[244:247], v[84:87]
    v_cvt_pk_bf16_f32 v112, v112, v113
    v_cvt_pk_bf16_f32 v113, v114, v115
    v_mfma_f32_16x16x32_bf16 v[120:123], v[152:155], v[248:251], v[120:123]
    v_cvt_pk_bf16_f32 v114, v116, v117
    v_cvt_pk_bf16_f32 v115, v118, v119
    s_waitcnt lgkmcnt(0)
    v_mfma_f32_16x16x32_bf16 v[120:123], v[156:159], v[164:167], v[120:123]
    s_add_u32 s82, s45, 180224
    v_mfma_f32_16x16x32_bf16 v[84:87], v[156:159], v[160:163], v[84:87]
    s_cmp_eq_u32 s90, 3
    s_cbranch_scc1 Lown_31
    buffer_store_dwordx4 v[112:115], v14, s[60:63], s82 offen sc1
Lownb_32:
    v_mfma_f32_16x16x32_bf16 v[48:51], v[156:159], v[252:255], v[48:51]
    s_nop 7
    v_cvt_pk_bf16_f32 v48, v48, v49
    v_cvt_pk_bf16_f32 v49, v50, v51
    v_cvt_pk_bf16_f32 v50, v84, v85
    v_cvt_pk_bf16_f32 v51, v86, v87
    s_add_u32 s82, s46, 196608
    s_cmp_eq_u32 s90, 4
    s_cbranch_scc1 Lown_33
    buffer_store_dwordx4 v[48:51], v14, s[60:63], s82 offen sc1
Lownb_34:
    v_cvt_pk_bf16_f32 v120, v120, v121
    v_cvt_pk_bf16_f32 v121, v122, v123
    s_add_u32 s82, s46, 212992
    s_cmp_eq_u32 s90, 5
    s_cbranch_scc1 Lown_35
    buffer_store_dwordx2 v[120:121], v11, s[60:63], s82 offen sc1
Lownb_36:
    s_waitcnt lgkmcnt(0)
    s_barrier
    s_waitcnt vmcnt(0) lgkmcnt(0)
    s_mov_b32 exec_lo, s97
    s_mov_b32 exec_hi, 0
    buffer_store_dwordx2 v[8:9], v3, s[60:63], s55 offen offset:64 sc1
    s_mov_b64 exec, -1
L_tail:
    s_nop 1
    s_cmp_ge_u32 s89, 14
    s_cbranch_scc1 L_st
    s_cmp_lg_u32 s90, 0
    s_cbranch_scc1 Low_37
    ds_read_b128 v[16:19], v2
Low_37:
    s_cmp_lg_u32 s90, 1
    s_cbranch_scc1 Low_38
    ds_read_b128 v[20:23], v2
Low_38:
    s_cmp_lg_u32 s90, 2
    s_cbranch_scc1 Low_39
    ds_read_b128 v[24:27], v2
Low_39:
    s_cmp_lg_u32 s90, 3
    s_cbranch_scc1 Low_40
    ds_read_b128 v[28:31], v2
Low_40:
    s_cmp_lg_u32 s90, 4
    s_cbranch_scc1 Low_41
    ds_read_b128 v[32:35], v2
Low_41:
    s_cmp_lg_u32 s90, 5
    s_cbranch_scc1 Low_42
    ds_read_b128 v[36:39], v2
Low_42:
    s_cmp_lg_u32 s90, 6
    s_cbranch_scc1 Low_43
    ds_read_b128 v[40:43], v2
Low_43:
    s_cmp_lg_u32 s90, 7
    s_cbranch_scc1 Low_44
    ds_read_b128 v[44:47], v2
Low_44:
    v_and_b32 v70, 60, v1
    v_and_b32 v71, 1, v1
    v_lshl_add_u32 v70, v71, 7, v70
    v_and_b32 v71, 2, v1
    v_lshl_add_u32 v70, v71, 5, v70
    s_add_u32 s77, s88, 4096
    s_mov_b32 s76, 0
    s_cmp_eq_u32 s89, 13
    s_cbranch_scc1 L_dynh
L_dyn:
    s_mov_b32 exec_lo, s97
    s_mov_b32 exec_hi, 0
    buffer_load_dwordx2 v[6:7], v11, s[60:63], s96 offen offset:64 sc1
    s_add_u32 s76, s76, 1
    s_waitcnt vmcnt(0)
    v_cmp_eq_u64 vcc, v[6:7], v[8:9]
    s_mov_b64 exec, -1
    s_cmp_gt_u32 s76, 131072
    s_cselect_b32 s75, s97, vcc_lo
    s_andn2_b32 s97, s97, s75
    s_bitcmp0_b32 s75, 0
    s_cbranch_scc1 Ldy_45
    buffer_load_dwordx4 v[16:19], v14, s[60:63], s88 offen sc1
Ldy_45:
    s_bitcmp0_b32 s75, 1
    s_cbranch_scc1 Ldy_46
    buffer_load_dwordx4 v[20:23], v14, s[60:63], s88 offen offset:1024 sc1
Ldy_46:
    s_bitcmp0_b32 s75, 2
    s_cbranch_scc1 Ldy_47
    buffer_load_dwordx4 v[24:27], v14, s[60:63], s88 offen offset:2048 sc1
Ldy_47:
    s_bitcmp0_b32 s75, 3
    s_cbranch_scc1 Ldy_48
    buffer_load_dwordx4 v[28:31], v14, s[60:63], s88 offen offset:3072 sc1
Ldy_48:
    s_bitcmp0_b32 s75, 4
    s_cbranch_scc1 Ldy_49
    buffer_load_dwordx4 v[32:35], v14, s[60:63], s77 offen sc1
Ldy_49:
    s_bitcmp0_b32 s75, 5
    s_cbranch_scc1 Ldy_50
    buffer_load_dwordx4 v[36:39], v14, s[60:63], s77 offen offset:1024 sc1
Ldy_50:
    s_bitcmp0_b32 s75, 6
    s_cbranch_scc1 Ldy_51
    buffer_load_dwordx4 v[40:43], v14, s[60:63], s77 offen offset:2048 sc1
Ldy_51:
    s_bitcmp0_b32 s75, 7
    s_cbranch_scc1 Ldy_52
    buffer_load_dwordx4 v[44:47], v14, s[60:63], s77 offen offset:3072 sc1
Ldy_52:
    s_cmp_lg_u32 s97, 0
    s_cbranch_scc1 L_dyn
L_dynb:
    s_waitcnt vmcnt(0) lgkmcnt(0)
    v_lshlrev_b32 v48, 16, v16
    v_and_b32 v49, 0xffff0000, v16
    v_lshlrev_b32 v50, 16, v17
    v_and_b32 v51, 0xffff0000, v17
    v_lshlrev_b32 v52, 16, v18
    v_and_b32 v53, 0xffff0000, v18
    v_lshlrev_b32 v54, 16, v19
    v_and_b32 v55, 0xffff0000, v19
    v_lshlrev_b32 v60, 16, v20
    v_and_b32 v61, 0xffff0000, v20
    v_pk_add_f32 v[48:49], v[48:49], v[60:61]
    v_lshlrev_b32 v62, 16, v21
    v_and_b32 v63, 0xffff0000, v21
    v_pk_add_f32 v[50:51], v[50:51], v[62:63]
    v_lshlrev_b32 v60, 16, v22
    v_and_b32 v61, 0xffff0000, v22
    v_pk_add_f32 v[52:53], v[52:53], v[60:61]
    v_lshlrev_b32 v62, 16, v23
    v_and_b32 v63, 0xffff0000, v23
    v_pk_add_f32 v[54:55], v[54:55], v[62:63]
    v_lshlrev_b32 v60, 16, v24
    v_and_b32 v61, 0xffff0000, v24
    v_pk_add_f32 v[48:49], v[48:49], v[60:61]
    v_lshlrev_b32 v62, 16, v25
    v_and_b32 v63, 0xffff0000, v25
    v_pk_add_f32 v[50:51], v[50:51], v[62:63]
    v_lshlrev_b32 v60, 16, v26
    v_and_b32 v61, 0xffff0000, v26
    v_pk_add_f32 v[52:53], v[52:53], v[60:61]
    v_lshlrev_b32 v62, 16, v27
    v_and_b32 v63, 0xffff0000, v27
    v_pk_add_f32 v[54:55], v[54:55], v[62:63]
    v_lshlrev_b32 v60, 16, v28
    v_and_b32 v61, 0xffff0000, v28
    v_pk_add_f32 v[48:49], v[48:49], v[60:61]
    v_lshlrev_b32 v62, 16, v29
    v_and_b32 v63, 0xffff0000, v29
    v_pk_add_f32 v[50:51], v[50:51], v[62:63]
    v_lshlrev_b32 v60, 16, v30
    v_and_b32 v61, 0xffff0000, v30
    v_pk_add_f32 v[52:53], v[52:53], v[60:61]
    v_lshlrev_b32 v62, 16, v31
    v_and_b32 v63, 0xffff0000, v31
    v_pk_add_f32 v[54:55], v[54:55], v[62:63]
    v_lshlrev_b32 v60, 16, v32
    v_and_b32 v61, 0xffff0000, v32
    v_pk_add_f32 v[48:49], v[48:49], v[60:61]
    v_lshlrev_b32 v62, 16, v33
    v_and_b32 v63, 0xffff0000, v33
    v_pk_add_f32 v[50:51], v[50:51], v[62:63]
    v_lshlrev_b32 v60, 16, v34
    v_and_b32 v61, 0xffff0000, v34
    v_pk_add_f32 v[52:53], v[52:53], v[60:61]
    v_lshlrev_b32 v62, 16, v35
    v_and_b32 v63, 0xffff0000, v35
    v_pk_add_f32 v[54:55], v[54:55], v[62:63]
    v_lshlrev_b32 v60, 16, v36
    v_and_b32 v61, 0xffff0000, v36
    v_pk_add_f32 v[48:49], v[48:49], v[60:61]
    v_lshlrev_b32 v62, 16, v37
    v_and_b32 v63, 0xffff0000, v37
    v_pk_add_f32 v[50:51], v[50:51], v[62:63]
    v_lshlrev_b32 v60, 16, v38
    v_and_b32 v61, 0xffff0000, v38
    v_pk_add_f32 v[52:53], v[52:53], v[60:61]
    v_lshlrev_b32 v62, 16, v39
    v_and_b32 v63, 0xffff0000, v39
    v_pk_add_f32 v[54:55], v[54:55], v[62:63]
    v_lshlrev_b32 v60, 16, v40
    v_and_b32 v61, 0xffff0000, v40
    v_pk_add_f32 v[48:49], v[48:49], v[60:61]
    v_lshlrev_b32 v62, 16, v41
    v_and_b32 v63, 0xffff0000, v41
    v_pk_add_f32 v[50:51], v[50:51], v[62:63]
    v_lshlrev_b32 v60, 16, v42
    v_and_b32 v61, 0xffff0000, v42
    v_pk_add_f32 v[52:53], v[52:53], v[60:61]
    v_lshlrev_b32 v62, 16, v43
    v_and_b32 v63, 0xffff0000, v43
    v_pk_add_f32 v[54:55], v[54:55], v[62:63]
    v_lshlrev_b32 v60, 16, v44
    v_and_b32 v61, 0xffff0000, v44
    v_pk_add_f32 v[48:49], v[48:49], v[60:61]
    v_lshlrev_b32 v62, 16, v45
    v_and_b32 v63, 0xffff0000, v45
    v_pk_add_f32 v[50:51], v[50:51], v[62:63]
    v_lshlrev_b32 v60, 16, v46
    v_and_b32 v61, 0xffff0000, v46
    v_pk_add_f32 v[52:53], v[52:53], v[60:61]
    v_lshlrev_b32 v62, 16, v47
    v_and_b32 v63, 0xffff0000, v47
    v_pk_add_f32 v[54:55], v[54:55], v[62:63]
    v_cvt_pk_bf16_f32 v64, v48, v49
    v_cvt_pk_bf16_f32 v65, v50, v51
    v_cvt_pk_bf16_f32 v66, v52, v53
    v_cvt_pk_bf16_f32 v67, v54, v55
    s_nop 0
    v_permlane16_swap_b32 v64, v66
    v_permlane16_swap_b32 v65, v67
    ds_bpermute_b32 v64, v70, v64
    ds_bpermute_b32 v65, v70, v65
    ds_bpermute_b32 v66, v70, v66
    ds_bpermute_b32 v67, v70, v67
    s_mov_b64 exec, s[78:79]
    s_waitcnt lgkmcnt(0)
    buffer_store_dwordx4 v[64:67], v4, s[56:59], s87 offen sc1
L_st:
L_end:
    s_endpgm
Lown_9:
    ds_write_b128 v2, v[16:19] offset:0
    buffer_store_dword v16, v14, s[36:39], 0 offen
    s_branch Lownb_10
Lown_11:
    ds_write_b128 v2, v[52:55] offset:0
    buffer_store_dword v52, v14, s[36:39], 0 offen
    s_branch Lownb_12
Lown_13:
    ds_write_b128 v2, v[88:91] offset:0
    buffer_store_dword v88, v14, s[36:39], 0 offen
    s_branch Lownb_14
Lown_15:
    ds_write_b128 v2, v[24:27] offset:0
    buffer_store_dword v24, v14, s[36:39], 0 offen
    s_branch Lownb_16
Lown_17:
    ds_write_b128 v2, v[60:63] offset:0
    buffer_store_dword v60, v14, s[36:39], 0 offen
    s_branch Lownb_18
Lown_19:
    ds_write_b128 v2, v[96:99] offset:0
    buffer_store_dword v96, v14, s[36:39], 0 offen
    s_branch Lownb_20
Lown_21:
    ds_write_b128 v2, v[32:35] offset:0
    buffer_store_dword v32, v14, s[36:39], 0 offen
    s_branch Lownb_22
Lown_23:
    ds_write_b128 v2, v[68:71] offset:0
    buffer_store_dword v68, v14, s[36:39], 0 offen
    s_branch Lownb_24
Lown_25:
    ds_write_b128 v2, v[104:107] offset:4096
    buffer_store_dword v104, v14, s[36:39], 0 offen
    s_branch Lownb_26
Lown_27:
    ds_write_b128 v2, v[40:43] offset:4096
    buffer_store_dword v40, v14, s[36:39], 0 offen
    s_branch Lownb_28
Lown_29:
    ds_write_b128 v2, v[76:79] offset:4096
    buffer_store_dword v76, v14, s[36:39], 0 offen
    s_branch Lownb_30
Lown_31:
    ds_write_b128 v2, v[112:115] offset:4096
    buffer_store_dword v112, v14, s[36:39], 0 offen
    s_branch Lownb_32
Lown_33:
    ds_write_b128 v2, v[48:51] offset:4096
    buffer_store_dword v48, v14, s[36:39], 0 offen
    s_branch Lownb_34
Lown_35:
    ds_write_b128 v2, v[120:123] offset:4096
    buffer_store_dword v120, v14, s[36:39], 0 offen
    s_branch Lownb_36
L_dynh:
    s_mov_b32 exec_lo, s97
    s_mov_b32 exec_hi, 0
    buffer_load_dwordx2 v[6:7], v11, s[60:63], s96 offen offset:64 sc1
    s_add_u32 s76, s76, 1
    s_waitcnt vmcnt(0)
    v_cmp_eq_u64 vcc, v[6:7], v[8:9]
    s_mov_b64 exec, -1
    s_cmp_gt_u32 s76, 131072
    s_cselect_b32 s75, s97, vcc_lo
    s_andn2_b32 s97, s97, s75
    s_bitcmp0_b32 s75, 0
    s_cbranch_scc1 Ldy_53
    buffer_load_dwordx2 v[16:17], v11, s[60:63], s88 offen sc1
Ldy_53:
    s_bitcmp0_b32 s75, 1
    s_cbranch_scc1 Ldy_54
    buffer_load_dwordx2 v[20:21], v11, s[60:63], s88 offen offset:1024 sc1
Ldy_54:
    s_bitcmp0_b32 s75, 2
    s_cbranch_scc1 Ldy_55
    buffer_load_dwordx2 v[24:25], v11, s[60:63], s88 offen offset:2048 sc1
Ldy_55:
    s_bitcmp0_b32 s75, 3
    s_cbranch_scc1 Ldy_56
    buffer_load_dwordx2 v[28:29], v11, s[60:63], s88 offen offset:3072 sc1
Ldy_56:
    s_bitcmp0_b32 s75, 4
    s_cbranch_scc1 Ldy_57
    buffer_load_dwordx2 v[32:33], v11, s[60:63], s77 offen sc1
Ldy_57:
    s_bitcmp0_b32 s75, 5
    s_cbranch_scc1 Ldy_58
    buffer_load_dwordx2 v[36:37], v11, s[60:63], s77 offen offset:1024 sc1
Ldy_58:
    s_bitcmp0_b32 s75, 6
    s_cbranch_scc1 Ldy_59
    buffer_load_dwordx2 v[40:41], v11, s[60:63], s77 offen offset:2048 sc1
Ldy_59:
    s_bitcmp0_b32 s75, 7
    s_cbranch_scc1 Ldy_60
    buffer_load_dwordx2 v[44:45], v11, s[60:63], s77 offen offset:3072 sc1
Ldy_60:
    s_cmp_lg_u32 s97, 0
    s_cbranch_scc1 L_dynh
    s_branch L_dynb

L_code_end:
.section .rodata,"a"
.p2align 6
.amdhsa_kernel concat_heads__gqa_block_cached__mha_block_cached__near_ridge_kernel
  .amdhsa_next_free_vgpr 256
  .amdhsa_next_free_sgpr 102
  .amdhsa_accum_offset 256
  .amdhsa_group_segment_fixed_size 0
  .amdhsa_kernarg_size 104
  .amdhsa_user_sgpr_count 2
  .amdhsa_user_sgpr_kernarg_segment_ptr 1
  .amdhsa_system_sgpr_workgroup_id_x 1
.end_amdhsa_kernel
```
